```python
import torch

def _softmax(x, axis=-1):
    return torch.softmax(x, dim=axis)
def _gelu(x):
    return torch.nn.functional.gelu(x, approximate="tanh")
def _silu(x):
    return torch.nn.functional.silu(x)
def _sigmoid(x):
    return torch.sigmoid(x)
def _layernorm(x, axis=-1, eps=1e-5):
    m = x.mean(dim=axis, keepdim=True)
    v = x.var(dim=axis, keepdim=True, unbiased=False)
    return (x - m) / torch.sqrt(v + eps)
def _scatter_add(tgt, idx, src, axis=0):
    return tgt.clone().index_add_(axis, idx, src)
def _segment_sum(src, seg, n):
    out = torch.zeros((n,) + src.shape[1:], dtype=src.dtype)
    return out.index_add_(0, seg, src)
def _pad(x, pw):
    flat = tuple(v for pair in reversed(pw) for v in pair)
    return torch.nn.functional.pad(x, flat)

kernel_name = 'standalone__gqa_softmax__near_ridge'

def setup_inputs():

    _w = (lambda a: (lambda t: t.to(torch.bfloat16) if t.is_floating_point() else t)(torch.as_tensor(a)))
    B, Hq, Hkv, Sq, Sk, D = 16, 32, 8, 64, 512, 128
    return {
        "q": _w((lambda *s: torch.randn(*s, dtype=torch.bfloat16) * 0.8)(B, Hq, Sq, D)),
        "k": _w((lambda *s: torch.randn(*s, dtype=torch.bfloat16) * 0.8)(B, Hkv, Sk, D)),
        "v": _w((lambda *s: torch.randn(*s, dtype=torch.bfloat16) * 0.05)(B, Hkv, Sk, D)),
    }

def reference(q, k, v):
    B, Hq, Sq, D = q.shape
    Hkv = k.shape[1]
    rep = Hq // Hkv
    k = (lambda x, n, axis: torch.repeat_interleave(x, n, dim=axis))(k, rep, axis=1)
    v = (lambda x, n, axis: torch.repeat_interleave(x, n, dim=axis))(v, rep, axis=1)
    scale = D ** -0.5
    scores = torch.einsum("bhqd,bhkd->bhqk", q, k) * scale
    p = _softmax(scores, axis=-1)
    return torch.einsum("bhqk,bhkd->bhqd", p, v)
```

```asm
; @launch grid=(256,1,1) block=(448,1,1) lds=163840
.amdgcn_target "amdgcn-amd-amdhsa--gfx950"
.text
.globl standalone__gqa_softmax__near_ridge_kernel
.p2align 8
.type standalone__gqa_softmax__near_ridge_kernel,@function
standalone__gqa_softmax__near_ridge_kernel:
s_load_dwordx4 s[4:7], s[0:1], 0
s_load_dwordx4 s[8:11], s[0:1], 16
s_cmp_ge_u32 s2, 256
s_cbranch_scc1 L_end
v_lshrrev_b32 v1, 6, v0
v_and_b32 v2, 63, v0
s_and_b32 s14, s2, 7
s_lshr_b32 s15, s2, 4
s_lshl_b32 s15, s15, 3
s_add_u32 s14, s14, s15
v_readfirstlane_b32 s16, v1
s_bfe_u32 s15, s2, 0x10003
s_lshl_b32 s17, s14, 17
s_lshl_b32 s18, s14, 16
s_lshl_b32 s19, s15, 15
s_add_u32 s18, s18, s19
v_lshlrev_b32 v16, 2, v0
v_add_u32 v16, 151552, v16
v_mov_b32 v29, 0
ds_write_b32 v16, v29
s_cmp_ge_u32 s16, 2
s_cbranch_scc1 L_consumer
s_getpc_b64 s[36:37]
L_pc:
s_add_u32 s36, s36, L_table-L_pc
s_addc_u32 s37, s37, 0
s_mov_b32 s38, 128
s_mov_b32 s39, 0x20000
v_lshrrev_b32 v3, 4, v2
v_and_b32 v4, 15, v2
v_lshlrev_b32 v4, 4, v4
s_lshl_b32 s44, s16, 11
v_add_u32 v4, s44, v4
v_lshl_add_u32 v6, v3, 12, v4
v_lshlrev_b32 v5, 4, v2
s_mul_i32 s42, s16, 8448
s_mul_i32 s43, s16, 8448
s_add_u32 s43, s43, 16768
s_lshl_b32 s85, s16, 13
s_add_u32 s17, s17, s85
s_lshl_b32 s44, s16, 8
s_add_u32 s44, s44, 151552
s_mov_b32 s30, 32768
s_mov_b32 s31, 0x20000
s_sub_u32 s22, 131072, s85
s_mov_b32 s23, 0x20000
s_mov_b32 s26, s22
s_mov_b32 s27, 0x20000
s_movk_i32 s40, 784
s_waitcnt lgkmcnt(0)
s_add_u32 s28, s4, s18
s_addc_u32 s29, s5, 0
s_add_u32 s20, s6, s17
s_addc_u32 s21, s7, 0
s_add_u32 s24, s8, s17
s_addc_u32 s25, s9, 0
s_add_u32 m0, s42, 16768
s_mov_b32 s45, 0
buffer_load_dwordx4 v6, s[28:31], s45 offen offset:0 nt lds
s_add_u32 m0, m0, s40
s_nop 0
buffer_load_dwordx4 v6, s[28:31], s45 offen offset:256 nt lds
s_add_u32 m0, m0, s40
s_nop 0
buffer_load_dwordx4 v6, s[28:31], s45 offen offset:512 nt lds
s_add_u32 m0, m0, s40
s_nop 0
buffer_load_dwordx4 v6, s[28:31], s45 offen offset:768 nt lds
s_add_u32 m0, m0, s40
s_nop 0
buffer_load_dwordx4 v6, s[28:31], s45 offen offset:1024 nt lds
s_add_u32 m0, m0, s40
s_nop 0
buffer_load_dwordx4 v6, s[28:31], s45 offen offset:1280 nt lds
s_add_u32 m0, m0, s40
s_nop 0
buffer_load_dwordx4 v6, s[28:31], s45 offen offset:1536 nt lds
s_add_u32 m0, m0, s40
s_nop 0
buffer_load_dwordx4 v6, s[28:31], s45 offen offset:1792 nt lds
s_mov_b32 m0, s44
s_nop 0
buffer_load_dword v29, s[36:39], 4 offen lds
s_add_u32 m0, s42, 0
s_mov_b32 s45, 0
buffer_load_dwordx4 v5, s[20:23], s45 offen offset:0 nt lds
s_add_u32 m0, m0, 16
s_nop 0
buffer_load_dwordx4 v5, s[20:23], s45 offen offset:1024 nt lds
s_add_u32 m0, m0, 16
s_nop 0
buffer_load_dwordx4 v5, s[20:23], s45 offen offset:2048 nt lds
s_add_u32 m0, m0, 16
s_nop 0
buffer_load_dwordx4 v5, s[20:23], s45 offen offset:3072 nt lds
s_add_u32 m0, m0, 4112
s_add_u32 s86, s45, 4096
buffer_load_dwordx4 v5, s[20:23], s86 offen offset:0 nt lds
s_add_u32 m0, m0, 16
s_nop 0
buffer_load_dwordx4 v5, s[20:23], s86 offen offset:1024 nt lds
s_add_u32 m0, m0, 16
s_nop 0
buffer_load_dwordx4 v5, s[20:23], s86 offen offset:2048 nt lds
s_add_u32 m0, m0, 16
s_nop 0
buffer_load_dwordx4 v5, s[20:23], s86 offen offset:3072 nt lds
s_mov_b32 m0, s44
s_nop 0
buffer_load_dword v29, s[36:39], 8 offen lds
s_add_u32 m0, s42, 33664
s_mov_b32 s45, 16384
buffer_load_dwordx4 v5, s[20:23], s45 offen offset:0 nt lds
s_add_u32 m0, m0, 16
s_nop 0
buffer_load_dwordx4 v5, s[20:23], s45 offen offset:1024 nt lds
s_add_u32 m0, m0, 16
s_nop 0
buffer_load_dwordx4 v5, s[20:23], s45 offen offset:2048 nt lds
s_add_u32 m0, m0, 16
s_nop 0
buffer_load_dwordx4 v5, s[20:23], s45 offen offset:3072 nt lds
s_add_u32 m0, m0, 4112
s_add_u32 s86, s45, 4096
buffer_load_dwordx4 v5, s[20:23], s86 offen offset:0 nt lds
s_add_u32 m0, m0, 16
s_nop 0
buffer_load_dwordx4 v5, s[20:23], s86 offen offset:1024 nt lds
s_add_u32 m0, m0, 16
s_nop 0
buffer_load_dwordx4 v5, s[20:23], s86 offen offset:2048 nt lds
s_add_u32 m0, m0, 16
s_nop 0
buffer_load_dwordx4 v5, s[20:23], s86 offen offset:3072 nt lds
s_mov_b32 m0, s44
s_nop 0
buffer_load_dword v29, s[36:39], 12 offen lds
s_barrier
s_waitcnt vmcnt(18)
s_add_u32 m0, s43, 33664
s_mov_b32 s45, 0
buffer_load_dwordx4 v5, s[24:27], s45 offen offset:0 nt lds
s_add_u32 m0, m0, 32
s_nop 0
buffer_load_dwordx4 v5, s[24:27], s45 offen offset:1024 nt lds
s_add_u32 m0, m0, 32
s_nop 0
buffer_load_dwordx4 v5, s[24:27], s45 offen offset:2048 nt lds
s_add_u32 m0, m0, 32
s_nop 0
buffer_load_dwordx4 v5, s[24:27], s45 offen offset:3072 nt lds
s_add_u32 m0, m0, 4128
s_add_u32 s86, s45, 4096
buffer_load_dwordx4 v5, s[24:27], s86 offen offset:0 nt lds
s_add_u32 m0, m0, 32
s_nop 0
buffer_load_dwordx4 v5, s[24:27], s86 offen offset:1024 nt lds
s_add_u32 m0, m0, 32
s_nop 0
buffer_load_dwordx4 v5, s[24:27], s86 offen offset:2048 nt lds
s_add_u32 m0, m0, 32
s_nop 0
buffer_load_dwordx4 v5, s[24:27], s86 offen offset:3072 nt lds
s_mov_b32 m0, s44
s_nop 0
buffer_load_dword v29, s[36:39], 16 offen lds
s_waitcnt vmcnt(18)
s_add_u32 m0, s42, 134656
s_mov_b32 s45, 16384
buffer_load_dwordx4 v6, s[28:31], s45 offen offset:0 nt lds
s_add_u32 m0, m0, s40
s_nop 0
buffer_load_dwordx4 v6, s[28:31], s45 offen offset:256 nt lds
s_add_u32 m0, m0, s40
s_nop 0
buffer_load_dwordx4 v6, s[28:31], s45 offen offset:512 nt lds
s_add_u32 m0, m0, s40
s_nop 0
buffer_load_dwordx4 v6, s[28:31], s45 offen offset:768 nt lds
s_add_u32 m0, m0, s40
s_nop 0
buffer_load_dwordx4 v6, s[28:31], s45 offen offset:1024 nt lds
s_add_u32 m0, m0, s40
s_nop 0
buffer_load_dwordx4 v6, s[28:31], s45 offen offset:1280 nt lds
s_add_u32 m0, m0, s40
s_nop 0
buffer_load_dwordx4 v6, s[28:31], s45 offen offset:1536 nt lds
s_add_u32 m0, m0, s40
s_nop 0
buffer_load_dwordx4 v6, s[28:31], s45 offen offset:1792 nt lds
s_mov_b32 m0, s44
s_nop 0
buffer_load_dword v29, s[36:39], 20 offen lds
v_and_b32 v3, 3, v2
v_lshlrev_b32 v3, 8, v3
v_lshl_add_u32 v15, v2, 2, v3
v_add_u32 v15, 152320, v15
s_mov_b32 s46, 67328
s_mov_b32 s49, 24
s_mov_b32 s45, 32768
s_mov_b32 s48, 0xa80600
L_lloop:
s_and_b32 s14, s48, 15
s_cbranch_scc0 L_lgo
s_branch L_lx
L_lw:
s_sleep 4
L_lx:
ds_read_b32 v8, v15
s_waitcnt lgkmcnt(0)
v_cmp_gt_u32 vcc, s14, v8
s_cbranch_vccnz L_lw
L_lgo:
s_lshr_b32 s48, s48, 4
s_sub_u32 s15, s45, 16384
s_cmp_eq_u32 s49, 72
s_cselect_b32 s46, 117888, s46
s_cbranch_scc1 L_lv
s_add_u32 m0, s46, s42
s_waitcnt vmcnt(18)
buffer_load_dwordx4 v5, s[20:23], s45 offen offset:0 nt lds
s_add_u32 m0, m0, 16
s_nop 0
buffer_load_dwordx4 v5, s[20:23], s45 offen offset:1024 nt lds
s_add_u32 m0, m0, 16
s_nop 0
buffer_load_dwordx4 v5, s[20:23], s45 offen offset:2048 nt lds
s_add_u32 m0, m0, 16
s_nop 0
buffer_load_dwordx4 v5, s[20:23], s45 offen offset:3072 nt lds
s_add_u32 m0, m0, 4112
s_add_u32 s86, s45, 4096
buffer_load_dwordx4 v5, s[20:23], s86 offen offset:0 nt lds
s_add_u32 m0, m0, 16
s_nop 0
buffer_load_dwordx4 v5, s[20:23], s86 offen offset:1024 nt lds
s_add_u32 m0, m0, 16
s_nop 0
buffer_load_dwordx4 v5, s[20:23], s86 offen offset:2048 nt lds
s_add_u32 m0, m0, 16
s_nop 0
buffer_load_dwordx4 v5, s[20:23], s86 offen offset:3072 nt lds
s_mov_b32 m0, s44
s_nop 0
buffer_load_dword v29, s[36:39], s49 offen lds
s_add_u32 s49, s49, 4
L_lv:
s_add_u32 m0, s46, s43
s_waitcnt vmcnt(18)
buffer_load_dwordx4 v5, s[24:27], s15 offen offset:0 nt lds
s_add_u32 m0, m0, 32
s_nop 0
buffer_load_dwordx4 v5, s[24:27], s15 offen offset:1024 nt lds
s_add_u32 m0, m0, 32
s_nop 0
buffer_load_dwordx4 v5, s[24:27], s15 offen offset:2048 nt lds
s_add_u32 m0, m0, 32
s_nop 0
buffer_load_dwordx4 v5, s[24:27], s15 offen offset:3072 nt lds
s_add_u32 m0, m0, 4128
s_add_u32 s86, s15, 4096
buffer_load_dwordx4 v5, s[24:27], s86 offen offset:0 nt lds
s_add_u32 m0, m0, 32
s_nop 0
buffer_load_dwordx4 v5, s[24:27], s86 offen offset:1024 nt lds
s_add_u32 m0, m0, 32
s_nop 0
buffer_load_dwordx4 v5, s[24:27], s86 offen offset:2048 nt lds
s_add_u32 m0, m0, 32
s_nop 0
buffer_load_dwordx4 v5, s[24:27], s86 offen offset:3072 nt lds
s_mov_b32 m0, s44
s_nop 0
buffer_load_dword v29, s[36:39], s49 offen lds
s_add_u32 s49, s49, 4
s_add_u32 s45, s45, 16384
s_add_u32 s46, s46, 33664
s_cmp_eq_u32 s46, 134656
s_cselect_b32 s46, 0, s46
s_cmp_lg_u32 s49, 56
s_cbranch_scc1 L_nv7
s_add_u32 m0, s43, 117888
s_mov_b32 s15, 114688
s_waitcnt vmcnt(18)
buffer_load_dwordx4 v5, s[24:27], s15 offen offset:0 nt lds
s_add_u32 m0, m0, 32
s_nop 0
buffer_load_dwordx4 v5, s[24:27], s15 offen offset:1024 nt lds
s_add_u32 m0, m0, 32
s_nop 0
buffer_load_dwordx4 v5, s[24:27], s15 offen offset:2048 nt lds
s_add_u32 m0, m0, 32
s_nop 0
buffer_load_dwordx4 v5, s[24:27], s15 offen offset:3072 nt lds
s_add_u32 m0, m0, 4128
s_add_u32 s86, s15, 4096
buffer_load_dwordx4 v5, s[24:27], s86 offen offset:0 nt lds
s_add_u32 m0, m0, 32
s_nop 0
buffer_load_dwordx4 v5, s[24:27], s86 offen offset:1024 nt lds
s_add_u32 m0, m0, 32
s_nop 0
buffer_load_dwordx4 v5, s[24:27], s86 offen offset:2048 nt lds
s_add_u32 m0, m0, 32
s_nop 0
buffer_load_dwordx4 v5, s[24:27], s86 offen offset:3072 nt lds
L_nv7:
s_cmp_lt_u32 s49, 72
s_cbranch_scc1 L_lloop
s_waitcnt vmcnt(0)
L_end:
s_endpgm
.p2align 7
L_table:
.long 0
.long 1
.long 2
.long 3
.long 4
.long 5
.long 6
.long 7
.long 8
.long 9
.long 10
.long 11
.long 12
.long 13
.long 14
.long 15
.long 16
.long 17
.long 18
.long 19
.long 20
.long 21
.long 22
.long 23
.long 24
.long 25
.long 26
.long 27
.long 28
.long 29
.long 30
.long 31
L_consumer:
s_cmp_ge_u32 s16, 3
s_cbranch_scc1 L_cons2
s_waitcnt lgkmcnt(0)
s_barrier
s_mov_b64 exec, 0
s_mov_b64 vcc, 0
s_setvskip -1, 0
s_nop 3
s_branch L_main
L_sdone:
s_setvskip 0, 0
s_endpgm
L_cons2:
s_sub_u32 s16, s16, 3
v_and_b32 v3, 1, v2
v_lshlrev_b32 v3, 8, v3
v_lshl_add_u32 v15, v2, 2, v3
v_add_u32 v15, 151552, v15
s_getpc_b64 s[36:37]
L_pc2:
s_add_u32 s36, s36, L_main-L_pc2
s_addc_u32 s37, s37, 0
s_mov_b32 s38, L_slow-L_main
s_mov_b32 s39, 0x20000
s_lshr_b32 s45, s2, 3
s_lshl_b32 s45, s45, 2
s_add_u32 s45, s45, s16
s_lshl_b32 s45, s45, 7
v_mov_b32 v3, 0
buffer_load_dword v1, v3, s[36:39], s45 offen
v_and_b32 v5, 15, v2
v_lshrrev_b32 v4, 4, v2
v_and_b32 v6, 1, v4
v_lshrrev_b32 v7, 1, v4
v_lshlrev_b32 v6, 7, v6
v_lshl_add_u32 v6, v7, 6, v6
v_mul_u32_u24 v10, 1040, v5
v_lshrrev_b32 v3, 3, v5
v_lshl_add_u32 v10, v3, 7, v10
v_add_u32 v10, v10, v6
v_add_u32 v11, 67328, v10
v_lshl_add_u32 v30, v5, 8, v6
v_lshrrev_b32 v3, 2, v2
v_and_b32 v8, 3, v2
v_mul_u32_u24 v9, 1056, v3
v_lshl_add_u32 v9, v8, 3, v9
v_add_u32 v12, 16768, v9
v_add_u32 v13, 84096, v9
v_add_u32 v14, 134656, v9
s_mul_i32 s47, s16, 2048
s_add_u32 s47, s47, 153600
v_lshlrev_b32 v9, 7, v3
v_lshl_add_u32 v9, v8, 3, v9
v_add_u32 v9, s47, v9
v_lshrrev_b32 v3, 3, v2
v_lshlrev_b32 v31, 8, v3
v_and_b32 v3, 7, v2
v_lshl_add_u32 v31, v3, 4, v31
s_lshl_b32 s45, s16, 13
v_lshlrev_b32 v26, 12, v7
v_bfe_u32 v3, v2, 2, 2
v_lshl_add_u32 v26, v3, 10, v26
v_and_b32 v3, 1, v4
v_lshl_add_u32 v26, v3, 8, v26
v_lshl_add_u32 v26, v8, 4, v26
v_add_u32 v26, s45, v26
s_mov_b32 s40, 0x3e0293ee
s_mov_b32 s41, 0x57800000
s_mov_b32 s76, 0x55555555
s_mov_b32 s77, s76
s_not_b64 s[78:79], s[76:77]
s_mov_b32 s80, 0x33333333
s_mov_b32 s81, s80
s_not_b64 s[82:83], s[80:81]
s_lshr_b32 s46, s16, 1
s_mov_b32 s45, 16768
s_cmp_eq_u32 s46, 0
s_cselect_b32 s45, s45, 134656
s_cselect_b32 s46, 1, 5
s_and_b32 s19, s16, 1
s_lshl_b32 s19, s19, 9
s_add_u32 s45, s45, s19
v_add_u32 v21, s45, v10
v_cmp_eq_u32 vcc, 0, v8
v_mov_b32 v3, 0x3f803f80
v_mov_b32 v5, 0
s_nop 0
v_cndmask_b32 v4, v5, v3, vcc
v_mov_b32 v5, v4
v_mov_b32 v6, v4
v_mov_b32 v7, v4
s_waitcnt lgkmcnt(0)
s_add_u32 s32, s10, s18
s_addc_u32 s33, s11, 0
s_mov_b32 s34, 32768
s_mov_b32 s35, 0x20000
s_add_u32 s20, s6, s17
s_addc_u32 s21, s7, 0
s_mov_b32 s22, 131072
s_mov_b32 s23, 0x20000
s_add_u32 s24, s8, s17
s_addc_u32 s25, s9, 0
s_mov_b32 s26, 131072
s_mov_b32 s27, 0x20000
s_barrier
s_branch L_main
L_spinq:
    s_sleep 4
    ds_read_b32 v27, v15
    s_waitcnt lgkmcnt(0)
    v_cmp_gt_u32 vcc, s46, v27
    s_cbranch_vccnz L_spinq
    s_branch L_backq
L_spinK0:
    s_sleep 2
    ds_read_b32 v28, v15
    s_waitcnt lgkmcnt(0)
    v_cmp_gt_u32 vcc, 2, v28
    s_cbranch_vccnz L_spinK0
    s_branch L_backK0
L_spinK1:
    s_sleep 2
    ds_read_b32 v27, v15
    s_waitcnt lgkmcnt(0)
    v_cmp_gt_u32 vcc, 3, v27
    s_cbranch_vccnz L_spinK1
    s_branch L_backK1
L_spinV0:
    s_sleep 2
    ds_read_b32 v28, v15
    s_waitcnt lgkmcnt(0)
    v_cmp_gt_u32 vcc, 4, v28
    s_cbranch_vccnz L_spinV0
    s_branch L_backV0
L_spinK2:
    s_sleep 2
    ds_read_b32 v27, v15
    s_waitcnt lgkmcnt(0)
    v_cmp_gt_u32 vcc, 6, v27
    s_cbranch_vccnz L_spinK2
    s_branch L_backK2
L_spinV1:
    s_sleep 2
    ds_read_b32 v28, v15
    s_waitcnt lgkmcnt(0)
    v_cmp_gt_u32 vcc, 7, v28
    s_cbranch_vccnz L_spinV1
    s_branch L_backV1
L_spinK3:
    s_sleep 2
    ds_read_b32 v27, v15
    s_waitcnt lgkmcnt(0)
    v_cmp_gt_u32 vcc, 8, v27
    s_cbranch_vccnz L_spinK3
    s_branch L_backK3
L_spinV2:
    s_sleep 2
    ds_read_b32 v28, v15
    s_waitcnt lgkmcnt(0)
    v_cmp_gt_u32 vcc, 9, v28
    s_cbranch_vccnz L_spinV2
    s_branch L_backV2
L_spinK4:
    s_sleep 2
    ds_read_b32 v27, v15
    s_waitcnt lgkmcnt(0)
    v_cmp_gt_u32 vcc, 10, v27
    s_cbranch_vccnz L_spinK4
    s_branch L_backK4
L_spinV3:
    s_sleep 2
    ds_read_b32 v28, v15
    s_waitcnt lgkmcnt(0)
    v_cmp_gt_u32 vcc, 11, v28
    s_cbranch_vccnz L_spinV3
    s_branch L_backV3
L_spinK5:
    s_sleep 2
    ds_read_b32 v27, v15
    s_waitcnt lgkmcnt(0)
    v_cmp_gt_u32 vcc, 12, v27
    s_cbranch_vccnz L_spinK5
    s_branch L_backK5
L_spinV4:
    s_sleep 2
    ds_read_b32 v28, v15
    s_waitcnt lgkmcnt(0)
    v_cmp_gt_u32 vcc, 13, v28
    s_cbranch_vccnz L_spinV4
    s_branch L_backV4
L_spinK6:
    s_sleep 2
    ds_read_b32 v27, v15
    s_waitcnt lgkmcnt(0)
    v_cmp_gt_u32 vcc, 14, v27
    s_cbranch_vccnz L_spinK6
    s_branch L_backK6
L_spinV5:
    s_sleep 2
    ds_read_b32 v28, v15
    s_waitcnt lgkmcnt(0)
    v_cmp_gt_u32 vcc, 15, v28
    s_cbranch_vccnz L_spinV5
    s_branch L_backV5
L_spinK7:
    s_sleep 2
    ds_read_b32 v27, v15
    s_waitcnt lgkmcnt(0)
    v_cmp_gt_u32 vcc, 16, v27
    s_cbranch_vccnz L_spinK7
    s_branch L_backK7
L_spinV6:
    s_sleep 2
    ds_read_b32 v28, v15
    s_waitcnt lgkmcnt(0)
    v_cmp_gt_u32 vcc, 17, v28
    s_cbranch_vccnz L_spinV6
    s_branch L_backV6
.p2align 3
L_main:
    ds_read_b32 v27, v15
    s_waitcnt lgkmcnt(0)
    v_cmp_gt_u32 vcc, s46, v27
    s_cbranch_vccnz L_spinq
L_backq:
    ds_read_b128 v[32:35], v21 offset:0
    ds_read_b128 v[36:39], v21 offset:16
    ds_read_b128 v[40:43], v21 offset:32
    ds_read_b128 v[44:47], v21 offset:48
    ds_read_b128 v[48:51], v21 offset:256
    ds_read_b128 v[52:55], v21 offset:272
    ds_read_b128 v[56:59], v21 offset:288
    ds_read_b128 v[60:63], v21 offset:304
    v_mov_b32 v22, s40
    v_mov_b32 v23, s40
    s_waitcnt lgkmcnt(7)
    v_lshlrev_b32 v144, 16, v32
    v_and_b32 v145, 0xffff0000, v32
    v_lshlrev_b32 v146, 16, v33
    v_and_b32 v147, 0xffff0000, v33
    v_pk_mul_f32 v[144:145], v[144:145], v[22:23]
    v_lshlrev_b32 v148, 16, v34
    v_and_b32 v149, 0xffff0000, v34
    v_pk_mul_f32 v[146:147], v[146:147], v[22:23]
    v_cvt_pk_bf16_f32 v32, v144, v145
    v_lshlrev_b32 v150, 16, v35
    v_and_b32 v151, 0xffff0000, v35
    v_pk_mul_f32 v[148:149], v[148:149], v[22:23]
    v_cvt_pk_bf16_f32 v33, v146, v147
    s_waitcnt lgkmcnt(6)
    v_lshlrev_b32 v152, 16, v36
    v_and_b32 v153, 0xffff0000, v36
    v_pk_mul_f32 v[150:151], v[150:151], v[22:23]
    v_cvt_pk_bf16_f32 v34, v148, v149
    v_lshlrev_b32 v154, 16, v37
    v_and_b32 v155, 0xffff0000, v37
    v_pk_mul_f32 v[152:153], v[152:153], v[22:23]
    v_cvt_pk_bf16_f32 v35, v150, v151
    v_lshlrev_b32 v156, 16, v38
    v_and_b32 v157, 0xffff0000, v38
    v_pk_mul_f32 v[154:155], v[154:155], v[22:23]
    v_cvt_pk_bf16_f32 v36, v152, v153
    v_lshlrev_b32 v158, 16, v39
    v_and_b32 v159, 0xffff0000, v39
    v_pk_mul_f32 v[156:157], v[156:157], v[22:23]
    v_cvt_pk_bf16_f32 v37, v154, v155
    s_waitcnt lgkmcnt(5)
    v_lshlrev_b32 v144, 16, v40
    v_and_b32 v145, 0xffff0000, v40
    v_pk_mul_f32 v[158:159], v[158:159], v[22:23]
    v_cvt_pk_bf16_f32 v38, v156, v157
    v_lshlrev_b32 v146, 16, v41
    v_and_b32 v147, 0xffff0000, v41
    v_pk_mul_f32 v[144:145], v[144:145], v[22:23]
    v_cvt_pk_bf16_f32 v39, v158, v159
    v_lshlrev_b32 v148, 16, v42
    v_and_b32 v149, 0xffff0000, v42
    v_pk_mul_f32 v[146:147], v[146:147], v[22:23]
    v_cvt_pk_bf16_f32 v40, v144, v145
    v_lshlrev_b32 v150, 16, v43
    v_and_b32 v151, 0xffff0000, v43
    v_pk_mul_f32 v[148:149], v[148:149], v[22:23]
    v_cvt_pk_bf16_f32 v41, v146, v147
    s_waitcnt lgkmcnt(4)
    v_lshlrev_b32 v152, 16, v44
    v_and_b32 v153, 0xffff0000, v44
    v_pk_mul_f32 v[150:151], v[150:151], v[22:23]
    v_cvt_pk_bf16_f32 v42, v148, v149
    v_lshlrev_b32 v154, 16, v45
    v_and_b32 v155, 0xffff0000, v45
    v_pk_mul_f32 v[152:153], v[152:153], v[22:23]
    v_cvt_pk_bf16_f32 v43, v150, v151
    v_lshlrev_b32 v156, 16, v46
    v_and_b32 v157, 0xffff0000, v46
    v_pk_mul_f32 v[154:155], v[154:155], v[22:23]
    v_cvt_pk_bf16_f32 v44, v152, v153
    v_lshlrev_b32 v158, 16, v47
    v_and_b32 v159, 0xffff0000, v47
    v_pk_mul_f32 v[156:157], v[156:157], v[22:23]
    v_cvt_pk_bf16_f32 v45, v154, v155
    s_waitcnt lgkmcnt(3)
    v_lshlrev_b32 v144, 16, v48
    v_and_b32 v145, 0xffff0000, v48
    v_pk_mul_f32 v[158:159], v[158:159], v[22:23]
    v_cvt_pk_bf16_f32 v46, v156, v157
    v_lshlrev_b32 v146, 16, v49
    v_and_b32 v147, 0xffff0000, v49
    v_pk_mul_f32 v[144:145], v[144:145], v[22:23]
    v_cvt_pk_bf16_f32 v47, v158, v159
    v_lshlrev_b32 v148, 16, v50
    v_and_b32 v149, 0xffff0000, v50
    v_pk_mul_f32 v[146:147], v[146:147], v[22:23]
    v_cvt_pk_bf16_f32 v48, v144, v145
    v_lshlrev_b32 v150, 16, v51
    v_and_b32 v151, 0xffff0000, v51
    v_pk_mul_f32 v[148:149], v[148:149], v[22:23]
    v_cvt_pk_bf16_f32 v49, v146, v147
    s_waitcnt lgkmcnt(2)
    v_lshlrev_b32 v152, 16, v52
    v_and_b32 v153, 0xffff0000, v52
    v_pk_mul_f32 v[150:151], v[150:151], v[22:23]
    v_cvt_pk_bf16_f32 v50, v148, v149
    v_lshlrev_b32 v154, 16, v53
    v_and_b32 v155, 0xffff0000, v53
    v_pk_mul_f32 v[152:153], v[152:153], v[22:23]
    v_cvt_pk_bf16_f32 v51, v150, v151
    v_lshlrev_b32 v156, 16, v54
    v_and_b32 v157, 0xffff0000, v54
    v_pk_mul_f32 v[154:155], v[154:155], v[22:23]
    v_cvt_pk_bf16_f32 v52, v152, v153
    v_lshlrev_b32 v158, 16, v55
    v_and_b32 v159, 0xffff0000, v55
    v_pk_mul_f32 v[156:157], v[156:157], v[22:23]
    v_cvt_pk_bf16_f32 v53, v154, v155
    s_waitcnt lgkmcnt(1)
    v_lshlrev_b32 v144, 16, v56
    v_and_b32 v145, 0xffff0000, v56
    v_pk_mul_f32 v[158:159], v[158:159], v[22:23]
    v_cvt_pk_bf16_f32 v54, v156, v157
    v_lshlrev_b32 v146, 16, v57
    v_and_b32 v147, 0xffff0000, v57
    v_pk_mul_f32 v[144:145], v[144:145], v[22:23]
    v_cvt_pk_bf16_f32 v55, v158, v159
    v_lshlrev_b32 v148, 16, v58
    v_and_b32 v149, 0xffff0000, v58
    v_pk_mul_f32 v[146:147], v[146:147], v[22:23]
    v_cvt_pk_bf16_f32 v56, v144, v145
    v_lshlrev_b32 v150, 16, v59
    v_and_b32 v151, 0xffff0000, v59
    v_pk_mul_f32 v[148:149], v[148:149], v[22:23]
    v_cvt_pk_bf16_f32 v57, v146, v147
    s_waitcnt lgkmcnt(0)
    v_lshlrev_b32 v152, 16, v60
    v_and_b32 v153, 0xffff0000, v60
    v_pk_mul_f32 v[150:151], v[150:151], v[22:23]
    v_cvt_pk_bf16_f32 v58, v148, v149
    v_lshlrev_b32 v154, 16, v61
    v_and_b32 v155, 0xffff0000, v61
    v_pk_mul_f32 v[152:153], v[152:153], v[22:23]
    v_cvt_pk_bf16_f32 v59, v150, v151
    v_lshlrev_b32 v156, 16, v62
    v_and_b32 v157, 0xffff0000, v62
    v_pk_mul_f32 v[154:155], v[154:155], v[22:23]
    v_cvt_pk_bf16_f32 v60, v152, v153
    v_lshlrev_b32 v158, 16, v63
    v_and_b32 v159, 0xffff0000, v63
    v_pk_mul_f32 v[156:157], v[156:157], v[22:23]
    v_cvt_pk_bf16_f32 v61, v154, v155
    v_pk_mul_f32 v[158:159], v[158:159], v[22:23]
    v_cvt_pk_bf16_f32 v62, v156, v157
    v_cvt_pk_bf16_f32 v63, v158, v159
    ds_read_b32 v28, v15
    s_waitcnt lgkmcnt(0)
    v_cmp_gt_u32 vcc, 2, v28
    s_cbranch_vccnz L_spinK0
L_backK0:
    ds_read_b128 v[64:67], v10 offset:0
    ds_read_b128 v[68:71], v10 offset:256
    ds_read_b128 v[72:75], v10 offset:16
    ds_read_b128 v[76:79], v10 offset:272
    ds_read_b128 v[80:83], v10 offset:32
    ds_read_b128 v[84:87], v10 offset:288
    ds_read_b128 v[88:91], v10 offset:48
    s_waitcnt lgkmcnt(6)
    v_mfma_f32_16x16x32_bf16 v[112:115], v[64:67], v[32:35], 0
    ds_read_b128 v[92:95], v10 offset:304
    v_mfma_f32_16x16x32_bf16 v[120:123], v[64:67], v[48:51], 0
    s_waitcnt lgkmcnt(6)
    v_mfma_f32_16x16x32_bf16 v[124:127], v[68:71], v[48:51], 0
    ds_read_b128 v[64:67], v10 offset:512
    v_mfma_f32_16x16x32_bf16 v[116:119], v[68:71], v[32:35], 0
    s_waitcnt lgkmcnt(6)
    v_mfma_f32_16x16x32_bf16 v[112:115], v[72:75], v[36:39], v[112:115]
    ds_read_b128 v[68:71], v10 offset:768
    v_mfma_f32_16x16x32_bf16 v[120:123], v[72:75], v[52:55], v[120:123]
    s_waitcnt lgkmcnt(6)
    v_mfma_f32_16x16x32_bf16 v[124:127], v[76:79], v[52:55], v[124:127]
    ds_read_b128 v[72:75], v10 offset:528
    v_mfma_f32_16x16x32_bf16 v[116:119], v[76:79], v[36:39], v[116:119]
    s_waitcnt lgkmcnt(3)
    v_mfma_f32_16x16x32_bf16 v[112:115], v[80:83], v[40:43], v[112:115]
    ds_read_b128 v[76:79], v10 offset:784
    v_mfma_f32_16x16x32_bf16 v[120:123], v[80:83], v[56:59], v[120:123]
    v_mfma_f32_16x16x32_bf16 v[124:127], v[84:87], v[56:59], v[124:127]
    ds_read_b128 v[80:83], v10 offset:544
    v_mfma_f32_16x16x32_bf16 v[116:119], v[84:87], v[40:43], v[116:119]
    v_mfma_f32_16x16x32_bf16 v[112:115], v[88:91], v[44:47], v[112:115]
    ds_read_b128 v[84:87], v10 offset:800
    v_mfma_f32_16x16x32_bf16 v[120:123], v[88:91], v[60:63], v[120:123]
    v_mfma_f32_16x16x32_bf16 v[124:127], v[92:95], v[60:63], v[124:127]
    ds_read_b128 v[88:91], v10 offset:560
    v_mfma_f32_16x16x32_bf16 v[116:119], v[92:95], v[44:47], v[116:119]
    s_waitcnt lgkmcnt(3)
    v_mfma_f32_16x16x32_bf16 v[128:131], v[64:67], v[32:35], 0
    ds_read_b128 v[92:95], v10 offset:816
    v_mfma_f32_16x16x32_bf16 v[136:139], v[64:67], v[48:51], 0
    v_max3_f32 v19, v112, v113, v114
    v_max3_f32 v20, v120, v121, v122
    v_mfma_f32_16x16x32_bf16 v[140:143], v[68:71], v[48:51], 0
    s_nop 0
    v_max3_f32 v19, v19, v115, v116
    v_max3_f32 v20, v20, v123, v124
    v_mfma_f32_16x16x32_bf16 v[132:135], v[68:71], v[32:35], 0
    v_max3_f32 v19, v19, v117, v118
    v_max3_f32 v20, v20, v125, v126
    v_mfma_f32_16x16x32_bf16 v[128:131], v[72:75], v[36:39], v[128:131]
    v_max_f32 v19, v19, v119
    v_max_f32 v20, v20, v127
    v_mfma_f32_16x16x32_bf16 v[136:139], v[72:75], v[52:55], v[136:139]
    v_mov_b32 v21, v19
    v_mov_b32 v8, v20
    v_mfma_f32_16x16x32_bf16 v[140:143], v[76:79], v[52:55], v[140:143]
    v_permlane16_swap_b32 v19, v21
    v_permlane16_swap_b32 v20, v8
    v_mfma_f32_16x16x32_bf16 v[132:135], v[76:79], v[36:39], v[132:135]
    v_max_f32 v19, v19, v21
    s_waitcnt lgkmcnt(0)
    v_mfma_f32_16x16x32_bf16 v[128:131], v[80:83], v[40:43], v[128:131]
    ds_read_b32 v27, v15
    v_max_f32 v20, v20, v8
    v_mfma_f32_16x16x32_bf16 v[136:139], v[80:83], v[56:59], v[136:139]
    v_mov_b32 v21, v19
    v_mov_b32 v8, v20
    v_mfma_f32_16x16x32_bf16 v[140:143], v[84:87], v[56:59], v[140:143]
    v_permlane32_swap_b32 v19, v21
    v_permlane32_swap_b32 v20, v8
    v_mfma_f32_16x16x32_bf16 v[132:135], v[84:87], v[40:43], v[132:135]
    v_max_f32 v19, v19, v21
    v_max_f32 v20, v20, v8
    v_mfma_f32_16x16x32_bf16 v[128:131], v[88:91], v[44:47], v[128:131]
    s_waitcnt lgkmcnt(0)
    v_cmp_gt_u32 vcc, 3, v27
    s_cbranch_vccnz L_spinK1
L_backK1:
    ds_read_b128 v[64:67], v10 offset:33664
    ds_read_b128 v[68:71], v10 offset:33920
    ds_read_b128 v[72:75], v10 offset:33680
    ds_read_b128 v[76:79], v10 offset:33936
    ds_read_b128 v[80:83], v10 offset:33696
    ds_read_b128 v[84:87], v10 offset:33952
    v_mfma_f32_16x16x32_bf16 v[136:139], v[88:91], v[60:63], v[136:139]
    v_sub_f32 v17, 0, v19
    v_sub_f32 v18, 0, v20
    v_mfma_f32_16x16x32_bf16 v[140:143], v[92:95], v[60:63], v[140:143]
    ds_read_b128 v[88:91], v10 offset:33712
    v_sub_f32 v96, 0, v19
    v_mfma_f32_16x16x32_bf16 v[132:135], v[92:95], v[44:47], v[132:135]
    v_sub_f32 v97, 0, v19
    v_sub_f32 v98, 0, v19
    v_sub_f32 v99, 0, v19
    v_sub_f32 v100, 0, v20
    v_sub_f32 v101, 0, v20
    v_sub_f32 v102, 0, v20
    v_sub_f32 v103, 0, v20
    s_waitcnt lgkmcnt(3)
    v_mfma_f32_16x16x32_bf16 v[144:147], v[64:67], v[32:35], v[96:99]
    ds_read_b128 v[92:95], v10 offset:33968
    v_add_f32 v112, v112, v17
    v_mfma_f32_16x16x32_bf16 v[152:155], v[64:67], v[48:51], v[100:103]
    v_add_f32 v113, v113, v17
    v_exp_f32 v112, v112
    v_mfma_f32_16x16x32_bf16 v[156:159], v[68:71], v[48:51], v[100:103]
    ds_read_b128 v[64:67], v10 offset:34176
    v_add_f32 v114, v114, v17
    v_mfma_f32_16x16x32_bf16 v[148:151], v[68:71], v[32:35], v[96:99]
    v_exp_f32 v113, v113
    v_mfma_f32_16x16x32_bf16 v[144:147], v[72:75], v[36:39], v[144:147]
    ds_read_b128 v[68:71], v10 offset:34432
    v_add_f32 v115, v115, v17
    v_mfma_f32_16x16x32_bf16 v[152:155], v[72:75], v[52:55], v[152:155]
    v_exp_f32 v114, v114
    v_mfma_f32_16x16x32_bf16 v[156:159], v[76:79], v[52:55], v[156:159]
    ds_read_b128 v[72:75], v10 offset:34192
    v_add_f32 v116, v116, v17
    v_mfma_f32_16x16x32_bf16 v[148:151], v[76:79], v[36:39], v[148:151]
    v_exp_f32 v115, v115
    s_waitcnt lgkmcnt(3)
    v_mfma_f32_16x16x32_bf16 v[144:147], v[80:83], v[40:43], v[144:147]
    ds_read_b128 v[76:79], v10 offset:34448
    v_add_f32 v117, v117, v17
    v_mfma_f32_16x16x32_bf16 v[152:155], v[80:83], v[56:59], v[152:155]
    v_exp_f32 v116, v116
    v_mfma_f32_16x16x32_bf16 v[156:159], v[84:87], v[56:59], v[156:159]
    ds_read_b128 v[80:83], v10 offset:34208
    v_add_f32 v118, v118, v17
    v_mfma_f32_16x16x32_bf16 v[148:151], v[84:87], v[40:43], v[148:151]
    v_exp_f32 v117, v117
    v_mfma_f32_16x16x32_bf16 v[144:147], v[88:91], v[44:47], v[144:147]
    ds_read_b128 v[84:87], v10 offset:34464
    v_add_f32 v119, v119, v17
    v_mfma_f32_16x16x32_bf16 v[152:155], v[88:91], v[60:63], v[152:155]
    v_exp_f32 v118, v118
    v_mfma_f32_16x16x32_bf16 v[156:159], v[92:95], v[60:63], v[156:159]
    ds_read_b128 v[88:91], v10 offset:34224
    v_add_f32 v120, v120, v18
    v_mfma_f32_16x16x32_bf16 v[148:151], v[92:95], v[44:47], v[148:151]
    v_cvt_pk_bf16_f32 v160, v112, v113
    v_cvt_pk_bf16_f32 v161, v114, v115
    v_exp_f32 v119, v119
    v_cvt_pk_bf16_f32 v162, v116, v117
    v_add_f32 v121, v121, v18
    v_exp_f32 v120, v120
    v_add_f32 v122, v122, v18
    v_exp_f32 v121, v121
    v_cvt_pk_bf16_f32 v163, v118, v119
    v_add_f32 v123, v123, v18
    v_exp_f32 v122, v122
    v_add_f32 v124, v124, v18
    v_exp_f32 v123, v123
    v_cvt_pk_bf16_f32 v164, v120, v121
    v_add_f32 v125, v125, v18
    v_exp_f32 v124, v124
    v_add_f32 v126, v126, v18
    v_exp_f32 v125, v125
    v_cvt_pk_bf16_f32 v165, v122, v123
    v_add_f32 v127, v127, v18
    v_exp_f32 v126, v126
    v_exp_f32 v127, v127
    v_cvt_pk_bf16_f32 v166, v124, v125
    v_cvt_pk_bf16_f32 v167, v126, v127
    s_waitcnt lgkmcnt(3)
    v_mfma_f32_16x16x32_bf16 v[112:115], v[64:67], v[32:35], v[96:99]
    ds_read_b128 v[92:95], v10 offset:34480
    v_add_f32 v128, v128, v17
    v_mfma_f32_16x16x32_bf16 v[120:123], v[64:67], v[48:51], v[100:103]
    v_add_f32 v129, v129, v17
    v_exp_f32 v128, v128
    v_mfma_f32_16x16x32_bf16 v[124:127], v[68:71], v[48:51], v[100:103]
    v_add_f32 v130, v130, v17
    v_exp_f32 v129, v129
    v_mfma_f32_16x16x32_bf16 v[116:119], v[68:71], v[32:35], v[96:99]
    v_add_f32 v131, v131, v17
    v_exp_f32 v130, v130
    v_mfma_f32_16x16x32_bf16 v[112:115], v[72:75], v[36:39], v[112:115]
    v_add_f32 v132, v132, v17
    v_exp_f32 v131, v131
    v_mfma_f32_16x16x32_bf16 v[120:123], v[72:75], v[52:55], v[120:123]
    v_add_f32 v133, v133, v17
    v_cvt_pk_bf16_f32 v168, v128, v129
    v_mfma_f32_16x16x32_bf16 v[124:127], v[76:79], v[52:55], v[124:127]
    v_exp_f32 v132, v132
    v_mfma_f32_16x16x32_bf16 v[116:119], v[76:79], v[36:39], v[116:119]
    v_add_f32 v134, v134, v17
    s_waitcnt lgkmcnt(0)
    v_mfma_f32_16x16x32_bf16 v[112:115], v[80:83], v[40:43], v[112:115]
    ds_read_b32 v28, v15
    v_exp_f32 v133, v133
    v_mfma_f32_16x16x32_bf16 v[120:123], v[80:83], v[56:59], v[120:123]
    v_add_f32 v135, v135, v17
    v_cvt_pk_bf16_f32 v169, v130, v131
    v_mfma_f32_16x16x32_bf16 v[124:127], v[84:87], v[56:59], v[124:127]
    v_exp_f32 v134, v134
    v_mfma_f32_16x16x32_bf16 v[116:119], v[84:87], v[40:43], v[116:119]
    v_add_f32 v136, v136, v18
    v_exp_f32 v135, v135
    v_mfma_f32_16x16x32_bf16 v[112:115], v[88:91], v[44:47], v[112:115]
    s_waitcnt lgkmcnt(0)
    v_cmp_gt_u32 vcc, 4, v28
    s_cbranch_vccnz L_spinV0
L_backV0:
    ds_read_b64_tr_b16 v[64:65], v12 offset:33664
    ds_read_b64_tr_b16 v[66:67], v12 offset:33920
    ds_read_b64_tr_b16 v[68:69], v12 offset:33696
    ds_read_b64_tr_b16 v[70:71], v12 offset:33952
    ds_read_b64_tr_b16 v[72:73], v12 offset:33728
    ds_read_b64_tr_b16 v[74:75], v12 offset:33984
    ds_read_b64_tr_b16 v[76:77], v12 offset:33760
    ds_read_b64_tr_b16 v[78:79], v12 offset:34016
    ds_read_b64_tr_b16 v[80:81], v12 offset:33792
    ds_read_b64_tr_b16 v[82:83], v12 offset:34048
    ds_read_b64_tr_b16 v[84:85], v12 offset:33824
    ds_read_b64_tr_b16 v[86:87], v12 offset:34080
    v_mfma_f32_16x16x32_bf16 v[120:123], v[88:91], v[60:63], v[120:123]
    v_add_f32 v137, v137, v18
    v_cvt_pk_bf16_f32 v170, v132, v133
    v_mfma_f32_16x16x32_bf16 v[124:127], v[92:95], v[60:63], v[124:127]
    ds_read_b64_tr_b16 v[88:89], v12 offset:33856
    ds_read_b64_tr_b16 v[90:91], v12 offset:34112
    v_mfma_f32_16x16x32_bf16 v[116:119], v[92:95], v[44:47], v[116:119]
    v_exp_f32 v136, v136
    s_waitcnt lgkmcnt(6)
    v_mfma_f32_16x16x32_bf16 v[192:195], v[64:67], v[160:163], 0
    ds_read_b64_tr_b16 v[92:93], v12 offset:33888
    ds_read_b64_tr_b16 v[94:95], v12 offset:34144
    v_mfma_f32_16x16x32_bf16 v[196:199], v[64:67], v[164:167], 0
    v_add_f32 v138, v138, v18
    v_exp_f32 v137, v137
    v_mfma_f32_16x16x32_bf16 v[108:111], v[4:7], v[164:167], 0
    v_add_f32 v139, v139, v18
    v_cvt_pk_bf16_f32 v171, v134, v135
    v_mfma_f32_16x16x32_bf16 v[104:107], v[4:7], v[160:163], 0
    v_exp_f32 v138, v138
    v_mfma_f32_16x16x32_bf16 v[200:203], v[68:71], v[160:163], 0
    ds_read_b64_tr_b16 v[64:65], v12 offset:34176
    ds_read_b64_tr_b16 v[66:67], v12 offset:34432
    v_mfma_f32_16x16x32_bf16 v[204:207], v[68:71], v[164:167], 0
    v_add_f32 v140, v140, v18
    v_exp_f32 v139, v139
    v_mfma_f32_16x16x32_bf16 v[212:215], v[72:75], v[164:167], 0
    ds_read_b64_tr_b16 v[68:69], v12 offset:34208
    ds_read_b64_tr_b16 v[70:71], v12 offset:34464
    v_mfma_f32_16x16x32_bf16 v[208:211], v[72:75], v[160:163], 0
    v_add_f32 v141, v141, v18
    v_cvt_pk_bf16_f32 v172, v136, v137
    v_mfma_f32_16x16x32_bf16 v[216:219], v[76:79], v[160:163], 0
    ds_read_b64_tr_b16 v[72:73], v12 offset:34240
    ds_read_b64_tr_b16 v[74:75], v12 offset:34496
    v_mfma_f32_16x16x32_bf16 v[220:223], v[76:79], v[164:167], 0
    v_exp_f32 v140, v140
    s_waitcnt lgkmcnt(6)
    v_mfma_f32_16x16x32_bf16 v[228:231], v[80:83], v[164:167], 0
    ds_read_b64_tr_b16 v[76:77], v12 offset:34272
    ds_read_b64_tr_b16 v[78:79], v12 offset:34528
    v_mfma_f32_16x16x32_bf16 v[224:227], v[80:83], v[160:163], 0
    v_add_f32 v142, v142, v18
    v_exp_f32 v141, v141
    v_mfma_f32_16x16x32_bf16 v[232:235], v[84:87], v[160:163], 0
    ds_read_b64_tr_b16 v[80:81], v12 offset:34304
    ds_read_b64_tr_b16 v[82:83], v12 offset:34560
    v_mfma_f32_16x16x32_bf16 v[236:239], v[84:87], v[164:167], 0
    v_add_f32 v143, v143, v18
    v_cvt_pk_bf16_f32 v173, v138, v139
    v_mfma_f32_16x16x32_bf16 v[244:247], v[88:91], v[164:167], 0
    ds_read_b64_tr_b16 v[84:85], v12 offset:34336
    ds_read_b64_tr_b16 v[86:87], v12 offset:34592
    v_mfma_f32_16x16x32_bf16 v[240:243], v[88:91], v[160:163], 0
    v_exp_f32 v142, v142
    v_mfma_f32_16x16x32_bf16 v[248:251], v[92:95], v[160:163], 0
    ds_read_b64_tr_b16 v[88:89], v12 offset:34368
    ds_read_b64_tr_b16 v[90:91], v12 offset:34624
    ds_read_b32 v27, v15
    v_mfma_f32_16x16x32_bf16 v[252:255], v[92:95], v[164:167], 0
    v_exp_f32 v143, v143
    v_cvt_pk_bf16_f32 v174, v140, v141
    v_cvt_pk_bf16_f32 v175, v142, v143
    s_waitcnt lgkmcnt(7)
    v_mfma_f32_16x16x32_bf16 v[192:195], v[64:67], v[168:171], v[192:195]
    ds_read_b64_tr_b16 v[92:93], v12 offset:34400
    ds_read_b64_tr_b16 v[94:95], v12 offset:34656
    v_mov_b32 v29, 6
    ds_write_b32 v16, v29
    v_mfma_f32_16x16x32_bf16 v[196:199], v[64:67], v[172:175], v[196:199]
    v_exp_f32 v144, v144
    v_mfma_f32_16x16x32_bf16 v[108:111], v[4:7], v[172:175], v[108:111]
    v_exp_f32 v145, v145
    v_mfma_f32_16x16x32_bf16 v[104:107], v[4:7], v[168:171], v[104:107]
    v_exp_f32 v146, v146
    v_mfma_f32_16x16x32_bf16 v[200:203], v[68:71], v[168:171], v[200:203]
    s_waitcnt lgkmcnt(3)
    v_cmp_gt_u32 vcc, 6, v27
    s_cbranch_vccnz L_spinK2
L_backK2:
    ds_read_b128 v[64:67], v11 offset:0
    v_mfma_f32_16x16x32_bf16 v[204:207], v[68:71], v[172:175], v[204:207]
    v_exp_f32 v147, v147
    v_mfma_f32_16x16x32_bf16 v[212:215], v[72:75], v[172:175], v[212:215]
    ds_read_b128 v[68:71], v11 offset:256
    v_cvt_pk_bf16_f32 v176, v144, v145
    v_mfma_f32_16x16x32_bf16 v[208:211], v[72:75], v[168:171], v[208:211]
    v_exp_f32 v148, v148
    v_mfma_f32_16x16x32_bf16 v[216:219], v[76:79], v[168:171], v[216:219]
    ds_read_b128 v[72:75], v11 offset:16
    v_exp_f32 v149, v149
    v_mfma_f32_16x16x32_bf16 v[220:223], v[76:79], v[172:175], v[220:223]
    v_cvt_pk_bf16_f32 v177, v146, v147
    s_waitcnt lgkmcnt(4)
    v_mfma_f32_16x16x32_bf16 v[228:231], v[80:83], v[172:175], v[228:231]
    ds_read_b128 v[76:79], v11 offset:272
    v_exp_f32 v150, v150
    v_mfma_f32_16x16x32_bf16 v[224:227], v[80:83], v[168:171], v[224:227]
    v_exp_f32 v151, v151
    v_mfma_f32_16x16x32_bf16 v[232:235], v[84:87], v[168:171], v[232:235]
    ds_read_b128 v[80:83], v11 offset:32
    v_cvt_pk_bf16_f32 v178, v148, v149
    v_mfma_f32_16x16x32_bf16 v[236:239], v[84:87], v[172:175], v[236:239]
    v_exp_f32 v152, v152
    v_mfma_f32_16x16x32_bf16 v[244:247], v[88:91], v[172:175], v[244:247]
    ds_read_b128 v[84:87], v11 offset:288
    v_exp_f32 v153, v153
    v_mfma_f32_16x16x32_bf16 v[240:243], v[88:91], v[168:171], v[240:243]
    v_exp_f32 v154, v154
    v_mfma_f32_16x16x32_bf16 v[248:251], v[92:95], v[168:171], v[248:251]
    ds_read_b128 v[88:91], v11 offset:48
    ds_read_b32 v28, v15
    v_mfma_f32_16x16x32_bf16 v[252:255], v[92:95], v[172:175], v[252:255]
    v_cvt_pk_bf16_f32 v179, v150, v151
    s_waitcnt lgkmcnt(4)
    v_mfma_f32_16x16x32_bf16 v[128:131], v[64:67], v[32:35], v[96:99]
    ds_read_b128 v[92:95], v11 offset:304
    v_exp_f32 v155, v155
    v_mfma_f32_16x16x32_bf16 v[136:139], v[64:67], v[48:51], v[100:103]
    v_exp_f32 v156, v156
    v_mfma_f32_16x16x32_bf16 v[140:143], v[68:71], v[48:51], v[100:103]
    s_waitcnt lgkmcnt(1)
    v_cmp_gt_u32 vcc, 7, v28
    s_cbranch_vccnz L_spinV1
L_backV1:
    ds_read_b64_tr_b16 v[64:65], v13 offset:0
    ds_read_b64_tr_b16 v[66:67], v13 offset:256
    v_mfma_f32_16x16x32_bf16 v[132:135], v[68:71], v[32:35], v[96:99]
    v_exp_f32 v157, v157
    v_mfma_f32_16x16x32_bf16 v[128:131], v[72:75], v[36:39], v[128:131]
    ds_read_b64_tr_b16 v[68:69], v13 offset:32
    ds_read_b64_tr_b16 v[70:71], v13 offset:288
    v_mfma_f32_16x16x32_bf16 v[136:139], v[72:75], v[52:55], v[136:139]
    v_exp_f32 v158, v158
    v_mfma_f32_16x16x32_bf16 v[140:143], v[76:79], v[52:55], v[140:143]
    ds_read_b64_tr_b16 v[72:73], v13 offset:64
    ds_read_b64_tr_b16 v[74:75], v13 offset:320
    v_mfma_f32_16x16x32_bf16 v[132:135], v[76:79], v[36:39], v[132:135]
    v_cvt_pk_bf16_f32 v180, v152, v153
    s_waitcnt lgkmcnt(6)
    v_mfma_f32_16x16x32_bf16 v[128:131], v[80:83], v[40:43], v[128:131]
    ds_read_b64_tr_b16 v[76:77], v13 offset:96
    ds_read_b64_tr_b16 v[78:79], v13 offset:352
    v_mfma_f32_16x16x32_bf16 v[136:139], v[80:83], v[56:59], v[136:139]
    v_exp_f32 v159, v159
    v_mfma_f32_16x16x32_bf16 v[140:143], v[84:87], v[56:59], v[140:143]
    ds_read_b64_tr_b16 v[80:81], v13 offset:128
    ds_read_b64_tr_b16 v[82:83], v13 offset:384
    v_mfma_f32_16x16x32_bf16 v[132:135], v[84:87], v[40:43], v[132:135]
    v_exp_f32 v112, v112
    v_mfma_f32_16x16x32_bf16 v[128:131], v[88:91], v[44:47], v[128:131]
    ds_read_b64_tr_b16 v[84:85], v13 offset:160
    ds_read_b64_tr_b16 v[86:87], v13 offset:416
    v_mfma_f32_16x16x32_bf16 v[136:139], v[88:91], v[60:63], v[136:139]
    v_exp_f32 v113, v113
    v_mfma_f32_16x16x32_bf16 v[140:143], v[92:95], v[60:63], v[140:143]
    ds_read_b64_tr_b16 v[88:89], v13 offset:192
    ds_read_b64_tr_b16 v[90:91], v13 offset:448
    v_mfma_f32_16x16x32_bf16 v[132:135], v[92:95], v[44:47], v[132:135]
    v_cvt_pk_bf16_f32 v181, v154, v155
    v_cvt_pk_bf16_f32 v182, v156, v157
    v_cvt_pk_bf16_f32 v183, v158, v159
    s_waitcnt lgkmcnt(6)
    v_mfma_f32_16x16x32_bf16 v[192:195], v[64:67], v[176:179], v[192:195]
    ds_read_b64_tr_b16 v[92:93], v13 offset:224
    ds_read_b64_tr_b16 v[94:95], v13 offset:480
    v_mfma_f32_16x16x32_bf16 v[196:199], v[64:67], v[180:183], v[196:199]
    v_exp_f32 v114, v114
    v_mfma_f32_16x16x32_bf16 v[108:111], v[4:7], v[180:183], v[108:111]
    v_exp_f32 v115, v115
    v_mfma_f32_16x16x32_bf16 v[104:107], v[4:7], v[176:179], v[104:107]
    v_exp_f32 v116, v116
    v_mfma_f32_16x16x32_bf16 v[200:203], v[68:71], v[176:179], v[200:203]
    ds_read_b128 v[64:67], v11 offset:512
    v_cvt_pk_bf16_f32 v184, v112, v113
    v_mfma_f32_16x16x32_bf16 v[204:207], v[68:71], v[180:183], v[204:207]
    v_exp_f32 v117, v117
    v_mfma_f32_16x16x32_bf16 v[212:215], v[72:75], v[180:183], v[212:215]
    ds_read_b128 v[68:71], v11 offset:768
    v_cvt_pk_bf16_f32 v185, v114, v115
    v_mfma_f32_16x16x32_bf16 v[208:211], v[72:75], v[176:179], v[208:211]
    v_exp_f32 v118, v118
    v_mfma_f32_16x16x32_bf16 v[216:219], v[76:79], v[176:179], v[216:219]
    ds_read_b128 v[72:75], v11 offset:528
    v_exp_f32 v119, v119
    v_mfma_f32_16x16x32_bf16 v[220:223], v[76:79], v[180:183], v[220:223]
    v_cvt_pk_bf16_f32 v186, v116, v117
    s_waitcnt lgkmcnt(3)
    v_mfma_f32_16x16x32_bf16 v[228:231], v[80:83], v[180:183], v[228:231]
    ds_read_b128 v[76:79], v11 offset:784
    v_exp_f32 v120, v120
    v_mfma_f32_16x16x32_bf16 v[224:227], v[80:83], v[176:179], v[224:227]
    v_exp_f32 v121, v121
    v_mfma_f32_16x16x32_bf16 v[232:235], v[84:87], v[176:179], v[232:235]
    ds_read_b128 v[80:83], v11 offset:544
    v_cvt_pk_bf16_f32 v187, v118, v119
    v_mfma_f32_16x16x32_bf16 v[236:239], v[84:87], v[180:183], v[236:239]
    v_exp_f32 v122, v122
    v_mfma_f32_16x16x32_bf16 v[244:247], v[88:91], v[180:183], v[244:247]
    ds_read_b128 v[84:87], v11 offset:800
    v_exp_f32 v123, v123
    v_mfma_f32_16x16x32_bf16 v[240:243], v[88:91], v[176:179], v[240:243]
    v_exp_f32 v124, v124
    v_mfma_f32_16x16x32_bf16 v[248:251], v[92:95], v[176:179], v[248:251]
    ds_read_b128 v[88:91], v11 offset:560
    v_cvt_pk_bf16_f32 v188, v120, v121
    v_mfma_f32_16x16x32_bf16 v[252:255], v[92:95], v[180:183], v[252:255]
    v_exp_f32 v125, v125
    s_waitcnt lgkmcnt(3)
    v_mfma_f32_16x16x32_bf16 v[144:147], v[64:67], v[32:35], v[96:99]
    ds_read_b128 v[92:95], v11 offset:816
    v_cvt_pk_bf16_f32 v189, v122, v123
    v_mfma_f32_16x16x32_bf16 v[152:155], v[64:67], v[48:51], v[100:103]
    v_exp_f32 v126, v126
    v_mfma_f32_16x16x32_bf16 v[156:159], v[68:71], v[48:51], v[100:103]
    ds_read_b64_tr_b16 v[64:65], v13 offset:512
    ds_read_b64_tr_b16 v[66:67], v13 offset:768
    v_mfma_f32_16x16x32_bf16 v[148:151], v[68:71], v[32:35], v[96:99]
    v_exp_f32 v127, v127
    v_mfma_f32_16x16x32_bf16 v[144:147], v[72:75], v[36:39], v[144:147]
    ds_read_b64_tr_b16 v[68:69], v13 offset:544
    ds_read_b64_tr_b16 v[70:71], v13 offset:800
    v_mfma_f32_16x16x32_bf16 v[152:155], v[72:75], v[52:55], v[152:155]
    v_exp_f32 v128, v128
    v_mfma_f32_16x16x32_bf16 v[156:159], v[76:79], v[52:55], v[156:159]
    ds_read_b64_tr_b16 v[72:73], v13 offset:576
    ds_read_b64_tr_b16 v[74:75], v13 offset:832
    v_mfma_f32_16x16x32_bf16 v[148:151], v[76:79], v[36:39], v[148:151]
    v_cvt_pk_bf16_f32 v190, v124, v125
    s_waitcnt lgkmcnt(6)
    v_mfma_f32_16x16x32_bf16 v[144:147], v[80:83], v[40:43], v[144:147]
    ds_read_b64_tr_b16 v[76:77], v13 offset:608
    ds_read_b64_tr_b16 v[78:79], v13 offset:864
    v_mfma_f32_16x16x32_bf16 v[152:155], v[80:83], v[56:59], v[152:155]
    v_exp_f32 v129, v129
    v_mfma_f32_16x16x32_bf16 v[156:159], v[84:87], v[56:59], v[156:159]
    ds_read_b64_tr_b16 v[80:81], v13 offset:640
    ds_read_b64_tr_b16 v[82:83], v13 offset:896
    v_mfma_f32_16x16x32_bf16 v[148:151], v[84:87], v[40:43], v[148:151]
    v_exp_f32 v130, v130
    v_mfma_f32_16x16x32_bf16 v[144:147], v[88:91], v[44:47], v[144:147]
    ds_read_b64_tr_b16 v[84:85], v13 offset:672
    ds_read_b64_tr_b16 v[86:87], v13 offset:928
    v_mfma_f32_16x16x32_bf16 v[152:155], v[88:91], v[60:63], v[152:155]
    v_exp_f32 v131, v131
    v_mfma_f32_16x16x32_bf16 v[156:159], v[92:95], v[60:63], v[156:159]
    ds_read_b64_tr_b16 v[88:89], v13 offset:704
    ds_read_b64_tr_b16 v[90:91], v13 offset:960
    ds_read_b32 v27, v15
    v_mfma_f32_16x16x32_bf16 v[148:151], v[92:95], v[44:47], v[148:151]
    v_cvt_pk_bf16_f32 v191, v126, v127
    s_waitcnt lgkmcnt(7)
    v_mfma_f32_16x16x32_bf16 v[192:195], v[64:67], v[184:187], v[192:195]
    ds_read_b64_tr_b16 v[92:93], v13 offset:736
    ds_read_b64_tr_b16 v[94:95], v13 offset:992
    v_mov_b32 v29, 8
    ds_write_b32 v16, v29
    v_mfma_f32_16x16x32_bf16 v[196:199], v[64:67], v[188:191], v[196:199]
    v_exp_f32 v132, v132
    v_mfma_f32_16x16x32_bf16 v[108:111], v[4:7], v[188:191], v[108:111]
    v_exp_f32 v133, v133
    v_mfma_f32_16x16x32_bf16 v[104:107], v[4:7], v[184:187], v[104:107]
    v_exp_f32 v134, v134
    v_mfma_f32_16x16x32_bf16 v[200:203], v[68:71], v[184:187], v[200:203]
    s_waitcnt lgkmcnt(3)
    v_cmp_gt_u32 vcc, 8, v27
    s_cbranch_vccnz L_spinK3
L_backK3:
    ds_read_b128 v[64:67], v11 offset:33664
    v_mfma_f32_16x16x32_bf16 v[204:207], v[68:71], v[188:191], v[204:207]
    v_exp_f32 v135, v135
    v_mfma_f32_16x16x32_bf16 v[212:215], v[72:75], v[188:191], v[212:215]
    ds_read_b128 v[68:71], v11 offset:33920
    v_cvt_pk_bf16_f32 v160, v128, v129
    v_mfma_f32_16x16x32_bf16 v[208:211], v[72:75], v[184:187], v[208:211]
    v_exp_f32 v136, v136
    v_mfma_f32_16x16x32_bf16 v[216:219], v[76:79], v[184:187], v[216:219]
    ds_read_b128 v[72:75], v11 offset:33680
    v_cvt_pk_bf16_f32 v161, v130, v131
    v_mfma_f32_16x16x32_bf16 v[220:223], v[76:79], v[188:191], v[220:223]
    v_cvt_pk_bf16_f32 v162, v132, v133
    s_waitcnt lgkmcnt(4)
    v_mfma_f32_16x16x32_bf16 v[228:231], v[80:83], v[188:191], v[228:231]
    ds_read_b128 v[76:79], v11 offset:33936
    v_exp_f32 v137, v137
    v_mfma_f32_16x16x32_bf16 v[224:227], v[80:83], v[184:187], v[224:227]
    v_exp_f32 v138, v138
    v_mfma_f32_16x16x32_bf16 v[232:235], v[84:87], v[184:187], v[232:235]
    ds_read_b128 v[80:83], v11 offset:33696
    v_cvt_pk_bf16_f32 v163, v134, v135
    v_mfma_f32_16x16x32_bf16 v[236:239], v[84:87], v[188:191], v[236:239]
    v_exp_f32 v139, v139
    v_mfma_f32_16x16x32_bf16 v[244:247], v[88:91], v[188:191], v[244:247]
    ds_read_b128 v[84:87], v11 offset:33952
    v_cvt_pk_bf16_f32 v164, v136, v137
    v_mfma_f32_16x16x32_bf16 v[240:243], v[88:91], v[184:187], v[240:243]
    v_exp_f32 v140, v140
    v_mfma_f32_16x16x32_bf16 v[248:251], v[92:95], v[184:187], v[248:251]
    ds_read_b128 v[88:91], v11 offset:33712
    ds_read_b32 v28, v15
    v_mfma_f32_16x16x32_bf16 v[252:255], v[92:95], v[188:191], v[252:255]
    v_exp_f32 v141, v141
    s_waitcnt lgkmcnt(4)
    v_mfma_f32_16x16x32_bf16 v[112:115], v[64:67], v[32:35], v[96:99]
    ds_read_b128 v[92:95], v11 offset:33968
    v_cvt_pk_bf16_f32 v165, v138, v139
    v_mfma_f32_16x16x32_bf16 v[120:123], v[64:67], v[48:51], v[100:103]
    v_exp_f32 v142, v142
    v_mfma_f32_16x16x32_bf16 v[124:127], v[68:71], v[48:51], v[100:103]
    s_waitcnt lgkmcnt(1)
    v_cmp_gt_u32 vcc, 9, v28
    s_cbranch_vccnz L_spinV2
L_backV2:
    ds_read_b64_tr_b16 v[64:65], v13 offset:33664
    ds_read_b64_tr_b16 v[66:67], v13 offset:33920
    v_mfma_f32_16x16x32_bf16 v[116:119], v[68:71], v[32:35], v[96:99]
    v_exp_f32 v143, v143
    v_mfma_f32_16x16x32_bf16 v[112:115], v[72:75], v[36:39], v[112:115]
    ds_read_b64_tr_b16 v[68:69], v13 offset:33696
    ds_read_b64_tr_b16 v[70:71], v13 offset:33952
    v_mfma_f32_16x16x32_bf16 v[120:123], v[72:75], v[52:55], v[120:123]
    v_exp_f32 v144, v144
    v_mfma_f32_16x16x32_bf16 v[124:127], v[76:79], v[52:55], v[124:127]
    ds_read_b64_tr_b16 v[72:73], v13 offset:33728
    ds_read_b64_tr_b16 v[74:75], v13 offset:33984
    v_mfma_f32_16x16x32_bf16 v[116:119], v[76:79], v[36:39], v[116:119]
    v_cvt_pk_bf16_f32 v166, v140, v141
    s_waitcnt lgkmcnt(6)
    v_mfma_f32_16x16x32_bf16 v[112:115], v[80:83], v[40:43], v[112:115]
    ds_read_b64_tr_b16 v[76:77], v13 offset:33760
    ds_read_b64_tr_b16 v[78:79], v13 offset:34016
    v_mfma_f32_16x16x32_bf16 v[120:123], v[80:83], v[56:59], v[120:123]
    v_exp_f32 v145, v145
    v_mfma_f32_16x16x32_bf16 v[124:127], v[84:87], v[56:59], v[124:127]
    ds_read_b64_tr_b16 v[80:81], v13 offset:33792
    ds_read_b64_tr_b16 v[82:83], v13 offset:34048
    v_mfma_f32_16x16x32_bf16 v[116:119], v[84:87], v[40:43], v[116:119]
    v_exp_f32 v146, v146
    v_mfma_f32_16x16x32_bf16 v[112:115], v[88:91], v[44:47], v[112:115]
    ds_read_b64_tr_b16 v[84:85], v13 offset:33824
    ds_read_b64_tr_b16 v[86:87], v13 offset:34080
    v_mfma_f32_16x16x32_bf16 v[120:123], v[88:91], v[60:63], v[120:123]
    v_exp_f32 v147, v147
    v_mfma_f32_16x16x32_bf16 v[124:127], v[92:95], v[60:63], v[124:127]
    ds_read_b64_tr_b16 v[88:89], v13 offset:33856
    ds_read_b64_tr_b16 v[90:91], v13 offset:34112
    v_mfma_f32_16x16x32_bf16 v[116:119], v[92:95], v[44:47], v[116:119]
    v_cvt_pk_bf16_f32 v167, v142, v143
    s_waitcnt lgkmcnt(6)
    v_mfma_f32_16x16x32_bf16 v[192:195], v[64:67], v[160:163], v[192:195]
    ds_read_b64_tr_b16 v[92:93], v13 offset:33888
    ds_read_b64_tr_b16 v[94:95], v13 offset:34144
    v_mfma_f32_16x16x32_bf16 v[196:199], v[64:67], v[164:167], v[196:199]
    v_exp_f32 v148, v148
    v_mfma_f32_16x16x32_bf16 v[108:111], v[4:7], v[164:167], v[108:111]
    v_exp_f32 v149, v149
    v_mfma_f32_16x16x32_bf16 v[104:107], v[4:7], v[160:163], v[104:107]
    v_exp_f32 v150, v150
    v_mfma_f32_16x16x32_bf16 v[200:203], v[68:71], v[160:163], v[200:203]
    ds_read_b128 v[64:67], v11 offset:34176
    v_cvt_pk_bf16_f32 v168, v144, v145
    v_mfma_f32_16x16x32_bf16 v[204:207], v[68:71], v[164:167], v[204:207]
    v_exp_f32 v151, v151
    v_mfma_f32_16x16x32_bf16 v[212:215], v[72:75], v[164:167], v[212:215]
    ds_read_b128 v[68:71], v11 offset:34432
    v_cvt_pk_bf16_f32 v169, v146, v147
    v_mfma_f32_16x16x32_bf16 v[208:211], v[72:75], v[160:163], v[208:211]
    v_exp_f32 v152, v152
    v_mfma_f32_16x16x32_bf16 v[216:219], v[76:79], v[160:163], v[216:219]
    ds_read_b128 v[72:75], v11 offset:34192
    v_cvt_pk_bf16_f32 v170, v148, v149
    v_mfma_f32_16x16x32_bf16 v[220:223], v[76:79], v[164:167], v[220:223]
    v_exp_f32 v153, v153
    s_waitcnt lgkmcnt(3)
    v_mfma_f32_16x16x32_bf16 v[228:231], v[80:83], v[164:167], v[228:231]
    ds_read_b128 v[76:79], v11 offset:34448
    v_cvt_pk_bf16_f32 v171, v150, v151
    v_mfma_f32_16x16x32_bf16 v[224:227], v[80:83], v[160:163], v[224:227]
    v_exp_f32 v154, v154
    v_mfma_f32_16x16x32_bf16 v[232:235], v[84:87], v[160:163], v[232:235]
    ds_read_b128 v[80:83], v11 offset:34208
    v_exp_f32 v155, v155
    v_mfma_f32_16x16x32_bf16 v[236:239], v[84:87], v[164:167], v[236:239]
    v_exp_f32 v156, v156
    v_mfma_f32_16x16x32_bf16 v[244:247], v[88:91], v[164:167], v[244:247]
    ds_read_b128 v[84:87], v11 offset:34464
    v_cvt_pk_bf16_f32 v172, v152, v153
    v_mfma_f32_16x16x32_bf16 v[240:243], v[88:91], v[160:163], v[240:243]
    v_exp_f32 v157, v157
    v_mfma_f32_16x16x32_bf16 v[248:251], v[92:95], v[160:163], v[248:251]
    ds_read_b128 v[88:91], v11 offset:34224
    v_cvt_pk_bf16_f32 v173, v154, v155
    v_mfma_f32_16x16x32_bf16 v[252:255], v[92:95], v[164:167], v[252:255]
    v_exp_f32 v158, v158
    s_waitcnt lgkmcnt(3)
    v_mfma_f32_16x16x32_bf16 v[128:131], v[64:67], v[32:35], v[96:99]
    ds_read_b128 v[92:95], v11 offset:34480
    v_exp_f32 v159, v159
    v_mfma_f32_16x16x32_bf16 v[136:139], v[64:67], v[48:51], v[100:103]
    v_exp_f32 v112, v112
    v_mfma_f32_16x16x32_bf16 v[140:143], v[68:71], v[48:51], v[100:103]
    ds_read_b64_tr_b16 v[64:65], v13 offset:34176
    ds_read_b64_tr_b16 v[66:67], v13 offset:34432
    v_mfma_f32_16x16x32_bf16 v[132:135], v[68:71], v[32:35], v[96:99]
    v_exp_f32 v113, v113
    v_mfma_f32_16x16x32_bf16 v[128:131], v[72:75], v[36:39], v[128:131]
    ds_read_b64_tr_b16 v[68:69], v13 offset:34208
    ds_read_b64_tr_b16 v[70:71], v13 offset:34464
    v_mfma_f32_16x16x32_bf16 v[136:139], v[72:75], v[52:55], v[136:139]
    v_exp_f32 v114, v114
    v_mfma_f32_16x16x32_bf16 v[140:143], v[76:79], v[52:55], v[140:143]
    ds_read_b64_tr_b16 v[72:73], v13 offset:34240
    ds_read_b64_tr_b16 v[74:75], v13 offset:34496
    v_mfma_f32_16x16x32_bf16 v[132:135], v[76:79], v[36:39], v[132:135]
    v_cvt_pk_bf16_f32 v174, v156, v157
    s_waitcnt lgkmcnt(6)
    v_mfma_f32_16x16x32_bf16 v[128:131], v[80:83], v[40:43], v[128:131]
    ds_read_b64_tr_b16 v[76:77], v13 offset:34272
    ds_read_b64_tr_b16 v[78:79], v13 offset:34528
    v_mfma_f32_16x16x32_bf16 v[136:139], v[80:83], v[56:59], v[136:139]
    v_exp_f32 v115, v115
    v_mfma_f32_16x16x32_bf16 v[140:143], v[84:87], v[56:59], v[140:143]
    ds_read_b64_tr_b16 v[80:81], v13 offset:34304
    ds_read_b64_tr_b16 v[82:83], v13 offset:34560
    v_mfma_f32_16x16x32_bf16 v[132:135], v[84:87], v[40:43], v[132:135]
    v_exp_f32 v116, v116
    v_mfma_f32_16x16x32_bf16 v[128:131], v[88:91], v[44:47], v[128:131]
    ds_read_b64_tr_b16 v[84:85], v13 offset:34336
    ds_read_b64_tr_b16 v[86:87], v13 offset:34592
    v_mfma_f32_16x16x32_bf16 v[136:139], v[88:91], v[60:63], v[136:139]
    v_exp_f32 v117, v117
    v_mfma_f32_16x16x32_bf16 v[140:143], v[92:95], v[60:63], v[140:143]
    ds_read_b64_tr_b16 v[88:89], v13 offset:34368
    ds_read_b64_tr_b16 v[90:91], v13 offset:34624
    ds_read_b32 v27, v15
    v_mfma_f32_16x16x32_bf16 v[132:135], v[92:95], v[44:47], v[132:135]
    v_cvt_pk_bf16_f32 v175, v158, v159
    s_waitcnt lgkmcnt(7)
    v_mfma_f32_16x16x32_bf16 v[192:195], v[64:67], v[168:171], v[192:195]
    ds_read_b64_tr_b16 v[92:93], v13 offset:34400
    ds_read_b64_tr_b16 v[94:95], v13 offset:34656
    v_mov_b32 v29, 10
    ds_write_b32 v16, v29
    v_mfma_f32_16x16x32_bf16 v[196:199], v[64:67], v[172:175], v[196:199]
    v_exp_f32 v118, v118
    v_mfma_f32_16x16x32_bf16 v[108:111], v[4:7], v[172:175], v[108:111]
    v_exp_f32 v119, v119
    v_mfma_f32_16x16x32_bf16 v[104:107], v[4:7], v[168:171], v[104:107]
    v_exp_f32 v120, v120
    v_mfma_f32_16x16x32_bf16 v[200:203], v[68:71], v[168:171], v[200:203]
    s_waitcnt lgkmcnt(3)
    v_cmp_gt_u32 vcc, 10, v27
    s_cbranch_vccnz L_spinK4
L_backK4:
    ds_read_b128 v[64:67], v10 offset:0
    v_mfma_f32_16x16x32_bf16 v[204:207], v[68:71], v[172:175], v[204:207]
    v_exp_f32 v121, v121
    v_mfma_f32_16x16x32_bf16 v[212:215], v[72:75], v[172:175], v[212:215]
    ds_read_b128 v[68:71], v10 offset:256
    v_cvt_pk_bf16_f32 v176, v112, v113
    v_mfma_f32_16x16x32_bf16 v[208:211], v[72:75], v[168:171], v[208:211]
    v_exp_f32 v122, v122
    v_mfma_f32_16x16x32_bf16 v[216:219], v[76:79], v[168:171], v[216:219]
    ds_read_b128 v[72:75], v10 offset:16
    v_cvt_pk_bf16_f32 v177, v114, v115
    v_mfma_f32_16x16x32_bf16 v[220:223], v[76:79], v[172:175], v[220:223]
    v_cvt_pk_bf16_f32 v178, v116, v117
    s_waitcnt lgkmcnt(4)
    v_mfma_f32_16x16x32_bf16 v[228:231], v[80:83], v[172:175], v[228:231]
    ds_read_b128 v[76:79], v10 offset:272
    v_cvt_pk_bf16_f32 v179, v118, v119
    v_mfma_f32_16x16x32_bf16 v[224:227], v[80:83], v[168:171], v[224:227]
    v_exp_f32 v123, v123
    v_mfma_f32_16x16x32_bf16 v[232:235], v[84:87], v[168:171], v[232:235]
    ds_read_b128 v[80:83], v10 offset:32
    v_cvt_pk_bf16_f32 v180, v120, v121
    v_mfma_f32_16x16x32_bf16 v[236:239], v[84:87], v[172:175], v[236:239]
    v_exp_f32 v124, v124
    v_mfma_f32_16x16x32_bf16 v[244:247], v[88:91], v[172:175], v[244:247]
    ds_read_b128 v[84:87], v10 offset:288
    v_exp_f32 v125, v125
    v_mfma_f32_16x16x32_bf16 v[240:243], v[88:91], v[168:171], v[240:243]
    v_exp_f32 v126, v126
    v_mfma_f32_16x16x32_bf16 v[248:251], v[92:95], v[168:171], v[248:251]
    ds_read_b128 v[88:91], v10 offset:48
    ds_read_b32 v28, v15
    v_mfma_f32_16x16x32_bf16 v[252:255], v[92:95], v[172:175], v[252:255]
    v_cvt_pk_bf16_f32 v181, v122, v123
    s_waitcnt lgkmcnt(4)
    v_mfma_f32_16x16x32_bf16 v[144:147], v[64:67], v[32:35], v[96:99]
    ds_read_b128 v[92:95], v10 offset:304
    v_exp_f32 v127, v127
    v_mfma_f32_16x16x32_bf16 v[152:155], v[64:67], v[48:51], v[100:103]
    v_exp_f32 v128, v128
    v_mfma_f32_16x16x32_bf16 v[156:159], v[68:71], v[48:51], v[100:103]
    s_waitcnt lgkmcnt(1)
    v_cmp_gt_u32 vcc, 11, v28
    s_cbranch_vccnz L_spinV3
L_backV3:
    ds_read_b64_tr_b16 v[64:65], v12 offset:0
    ds_read_b64_tr_b16 v[66:67], v12 offset:256
    v_mfma_f32_16x16x32_bf16 v[148:151], v[68:71], v[32:35], v[96:99]
    v_exp_f32 v129, v129
    v_mfma_f32_16x16x32_bf16 v[144:147], v[72:75], v[36:39], v[144:147]
    ds_read_b64_tr_b16 v[68:69], v12 offset:32
    ds_read_b64_tr_b16 v[70:71], v12 offset:288
    v_mfma_f32_16x16x32_bf16 v[152:155], v[72:75], v[52:55], v[152:155]
    v_exp_f32 v130, v130
    v_mfma_f32_16x16x32_bf16 v[156:159], v[76:79], v[52:55], v[156:159]
    ds_read_b64_tr_b16 v[72:73], v12 offset:64
    ds_read_b64_tr_b16 v[74:75], v12 offset:320
    v_mfma_f32_16x16x32_bf16 v[148:151], v[76:79], v[36:39], v[148:151]
    v_cvt_pk_bf16_f32 v182, v124, v125
    s_waitcnt lgkmcnt(6)
    v_mfma_f32_16x16x32_bf16 v[144:147], v[80:83], v[40:43], v[144:147]
    ds_read_b64_tr_b16 v[76:77], v12 offset:96
    ds_read_b64_tr_b16 v[78:79], v12 offset:352
    v_mfma_f32_16x16x32_bf16 v[152:155], v[80:83], v[56:59], v[152:155]
    v_exp_f32 v131, v131
    v_mfma_f32_16x16x32_bf16 v[156:159], v[84:87], v[56:59], v[156:159]
    ds_read_b64_tr_b16 v[80:81], v12 offset:128
    ds_read_b64_tr_b16 v[82:83], v12 offset:384
    v_mfma_f32_16x16x32_bf16 v[148:151], v[84:87], v[40:43], v[148:151]
    v_exp_f32 v132, v132
    v_mfma_f32_16x16x32_bf16 v[144:147], v[88:91], v[44:47], v[144:147]
    ds_read_b64_tr_b16 v[84:85], v12 offset:160
    ds_read_b64_tr_b16 v[86:87], v12 offset:416
    v_mfma_f32_16x16x32_bf16 v[152:155], v[88:91], v[60:63], v[152:155]
    v_exp_f32 v133, v133
    v_mfma_f32_16x16x32_bf16 v[156:159], v[92:95], v[60:63], v[156:159]
    ds_read_b64_tr_b16 v[88:89], v12 offset:192
    ds_read_b64_tr_b16 v[90:91], v12 offset:448
    v_mfma_f32_16x16x32_bf16 v[148:151], v[92:95], v[44:47], v[148:151]
    v_cvt_pk_bf16_f32 v183, v126, v127
    s_waitcnt lgkmcnt(6)
    v_mfma_f32_16x16x32_bf16 v[192:195], v[64:67], v[176:179], v[192:195]
    ds_read_b64_tr_b16 v[92:93], v12 offset:224
    ds_read_b64_tr_b16 v[94:95], v12 offset:480
    v_mfma_f32_16x16x32_bf16 v[196:199], v[64:67], v[180:183], v[196:199]
    v_exp_f32 v134, v134
    v_mfma_f32_16x16x32_bf16 v[108:111], v[4:7], v[180:183], v[108:111]
    v_exp_f32 v135, v135
    v_mfma_f32_16x16x32_bf16 v[104:107], v[4:7], v[176:179], v[104:107]
    v_exp_f32 v136, v136
    v_mfma_f32_16x16x32_bf16 v[200:203], v[68:71], v[176:179], v[200:203]
    ds_read_b128 v[64:67], v10 offset:512
    v_cvt_pk_bf16_f32 v184, v128, v129
    v_mfma_f32_16x16x32_bf16 v[204:207], v[68:71], v[180:183], v[204:207]
    v_exp_f32 v137, v137
    v_mfma_f32_16x16x32_bf16 v[212:215], v[72:75], v[180:183], v[212:215]
    ds_read_b128 v[68:71], v10 offset:768
    v_cvt_pk_bf16_f32 v185, v130, v131
    v_mfma_f32_16x16x32_bf16 v[208:211], v[72:75], v[176:179], v[208:211]
    v_exp_f32 v138, v138
    v_mfma_f32_16x16x32_bf16 v[216:219], v[76:79], v[176:179], v[216:219]
    ds_read_b128 v[72:75], v10 offset:528
    v_cvt_pk_bf16_f32 v186, v132, v133
    v_mfma_f32_16x16x32_bf16 v[220:223], v[76:79], v[180:183], v[220:223]
    v_cvt_pk_bf16_f32 v187, v134, v135
    s_waitcnt lgkmcnt(3)
    v_mfma_f32_16x16x32_bf16 v[228:231], v[80:83], v[180:183], v[228:231]
    ds_read_b128 v[76:79], v10 offset:784
    v_exp_f32 v139, v139
    v_mfma_f32_16x16x32_bf16 v[224:227], v[80:83], v[176:179], v[224:227]
    v_exp_f32 v140, v140
    v_mfma_f32_16x16x32_bf16 v[232:235], v[84:87], v[176:179], v[232:235]
    ds_read_b128 v[80:83], v10 offset:544
    v_cvt_pk_bf16_f32 v188, v136, v137
    v_mfma_f32_16x16x32_bf16 v[236:239], v[84:87], v[180:183], v[236:239]
    v_exp_f32 v141, v141
    v_mfma_f32_16x16x32_bf16 v[244:247], v[88:91], v[180:183], v[244:247]
    ds_read_b128 v[84:87], v10 offset:800
    v_cvt_pk_bf16_f32 v189, v138, v139
    v_mfma_f32_16x16x32_bf16 v[240:243], v[88:91], v[176:179], v[240:243]
    v_exp_f32 v142, v142
    v_mfma_f32_16x16x32_bf16 v[248:251], v[92:95], v[176:179], v[248:251]
    ds_read_b128 v[88:91], v10 offset:560
    v_exp_f32 v143, v143
    v_mfma_f32_16x16x32_bf16 v[252:255], v[92:95], v[180:183], v[252:255]
    v_cvt_pk_bf16_f32 v190, v140, v141
    s_waitcnt lgkmcnt(3)
    v_mfma_f32_16x16x32_bf16 v[112:115], v[64:67], v[32:35], v[96:99]
    ds_read_b128 v[92:95], v10 offset:816
    v_cvt_pk_bf16_f32 v191, v142, v143
    v_mfma_f32_16x16x32_bf16 v[120:123], v[64:67], v[48:51], v[100:103]
    v_exp_f32 v144, v144
    v_mfma_f32_16x16x32_bf16 v[124:127], v[68:71], v[48:51], v[100:103]
    ds_read_b64_tr_b16 v[64:65], v12 offset:512
    ds_read_b64_tr_b16 v[66:67], v12 offset:768
    v_mfma_f32_16x16x32_bf16 v[116:119], v[68:71], v[32:35], v[96:99]
    v_exp_f32 v145, v145
    v_mfma_f32_16x16x32_bf16 v[112:115], v[72:75], v[36:39], v[112:115]
    ds_read_b64_tr_b16 v[68:69], v12 offset:544
    ds_read_b64_tr_b16 v[70:71], v12 offset:800
    v_mfma_f32_16x16x32_bf16 v[120:123], v[72:75], v[52:55], v[120:123]
    v_exp_f32 v146, v146
    v_mfma_f32_16x16x32_bf16 v[124:127], v[76:79], v[52:55], v[124:127]
    ds_read_b64_tr_b16 v[72:73], v12 offset:576
    ds_read_b64_tr_b16 v[74:75], v12 offset:832
    v_mfma_f32_16x16x32_bf16 v[116:119], v[76:79], v[36:39], v[116:119]
    v_exp_f32 v147, v147
    s_waitcnt lgkmcnt(6)
    v_mfma_f32_16x16x32_bf16 v[112:115], v[80:83], v[40:43], v[112:115]
    ds_read_b64_tr_b16 v[76:77], v12 offset:608
    ds_read_b64_tr_b16 v[78:79], v12 offset:864
    v_mfma_f32_16x16x32_bf16 v[120:123], v[80:83], v[56:59], v[120:123]
    v_exp_f32 v148, v148
    v_mfma_f32_16x16x32_bf16 v[124:127], v[84:87], v[56:59], v[124:127]
    ds_read_b64_tr_b16 v[80:81], v12 offset:640
    ds_read_b64_tr_b16 v[82:83], v12 offset:896
    v_mfma_f32_16x16x32_bf16 v[116:119], v[84:87], v[40:43], v[116:119]
    v_exp_f32 v149, v149
    v_mfma_f32_16x16x32_bf16 v[112:115], v[88:91], v[44:47], v[112:115]
    ds_read_b64_tr_b16 v[84:85], v12 offset:672
    ds_read_b64_tr_b16 v[86:87], v12 offset:928
    v_mfma_f32_16x16x32_bf16 v[120:123], v[88:91], v[60:63], v[120:123]
    v_exp_f32 v150, v150
    v_mfma_f32_16x16x32_bf16 v[124:127], v[92:95], v[60:63], v[124:127]
    ds_read_b64_tr_b16 v[88:89], v12 offset:704
    ds_read_b64_tr_b16 v[90:91], v12 offset:960
    ds_read_b32 v27, v15
    v_mfma_f32_16x16x32_bf16 v[116:119], v[92:95], v[44:47], v[116:119]
    v_cvt_pk_bf16_f32 v160, v144, v145
    s_waitcnt lgkmcnt(7)
    v_mfma_f32_16x16x32_bf16 v[192:195], v[64:67], v[184:187], v[192:195]
    ds_read_b64_tr_b16 v[92:93], v12 offset:736
    ds_read_b64_tr_b16 v[94:95], v12 offset:992
    v_mfma_f32_16x16x32_bf16 v[196:199], v[64:67], v[188:191], v[196:199]
    v_exp_f32 v151, v151
    v_mfma_f32_16x16x32_bf16 v[108:111], v[4:7], v[188:191], v[108:111]
    v_exp_f32 v152, v152
    v_mfma_f32_16x16x32_bf16 v[104:107], v[4:7], v[184:187], v[104:107]
    v_exp_f32 v153, v153
    v_mfma_f32_16x16x32_bf16 v[200:203], v[68:71], v[184:187], v[200:203]
    s_waitcnt lgkmcnt(2)
    v_cmp_gt_u32 vcc, 12, v27
    s_cbranch_vccnz L_spinK5
L_backK5:
    ds_read_b128 v[64:67], v10 offset:33664
    v_mfma_f32_16x16x32_bf16 v[204:207], v[68:71], v[188:191], v[204:207]
    v_exp_f32 v154, v154
    v_mfma_f32_16x16x32_bf16 v[212:215], v[72:75], v[188:191], v[212:215]
    ds_read_b128 v[68:71], v10 offset:33920
    v_cvt_pk_bf16_f32 v161, v146, v147
    v_mfma_f32_16x16x32_bf16 v[208:211], v[72:75], v[184:187], v[208:211]
    v_exp_f32 v155, v155
    v_mfma_f32_16x16x32_bf16 v[216:219], v[76:79], v[184:187], v[216:219]
    ds_read_b128 v[72:75], v10 offset:33680
    v_cvt_pk_bf16_f32 v162, v148, v149
    v_mfma_f32_16x16x32_bf16 v[220:223], v[76:79], v[188:191], v[220:223]
    v_cvt_pk_bf16_f32 v163, v150, v151
    s_waitcnt lgkmcnt(3)
    v_mfma_f32_16x16x32_bf16 v[228:231], v[80:83], v[188:191], v[228:231]
    ds_read_b128 v[76:79], v10 offset:33936
    v_cvt_pk_bf16_f32 v164, v152, v153
    v_mfma_f32_16x16x32_bf16 v[224:227], v[80:83], v[184:187], v[224:227]
    v_exp_f32 v156, v156
    v_mfma_f32_16x16x32_bf16 v[232:235], v[84:87], v[184:187], v[232:235]
    ds_read_b128 v[80:83], v10 offset:33696
    v_exp_f32 v157, v157
    v_mfma_f32_16x16x32_bf16 v[236:239], v[84:87], v[188:191], v[236:239]
    v_exp_f32 v158, v158
    v_mfma_f32_16x16x32_bf16 v[244:247], v[88:91], v[188:191], v[244:247]
    ds_read_b128 v[84:87], v10 offset:33952
    v_cvt_pk_bf16_f32 v165, v154, v155
    v_mfma_f32_16x16x32_bf16 v[240:243], v[88:91], v[184:187], v[240:243]
    v_exp_f32 v159, v159
    v_mfma_f32_16x16x32_bf16 v[248:251], v[92:95], v[184:187], v[248:251]
    ds_read_b128 v[88:91], v10 offset:33712
    ds_read_b32 v28, v15
    v_mfma_f32_16x16x32_bf16 v[252:255], v[92:95], v[188:191], v[252:255]
    v_cvt_pk_bf16_f32 v166, v156, v157
    s_waitcnt lgkmcnt(4)
    v_mfma_f32_16x16x32_bf16 v[128:131], v[64:67], v[32:35], v[96:99]
    ds_read_b128 v[92:95], v10 offset:33968
    v_cvt_pk_bf16_f32 v167, v158, v159
    v_mfma_f32_16x16x32_bf16 v[136:139], v[64:67], v[48:51], v[100:103]
    v_exp_f32 v112, v112
    v_mfma_f32_16x16x32_bf16 v[140:143], v[68:71], v[48:51], v[100:103]
    s_waitcnt lgkmcnt(1)
    v_cmp_gt_u32 vcc, 13, v28
    s_cbranch_vccnz L_spinV4
L_backV4:
    ds_read_b64_tr_b16 v[64:65], v12 offset:33664
    ds_read_b64_tr_b16 v[66:67], v12 offset:33920
    v_mfma_f32_16x16x32_bf16 v[132:135], v[68:71], v[32:35], v[96:99]
    v_exp_f32 v113, v113
    v_mfma_f32_16x16x32_bf16 v[128:131], v[72:75], v[36:39], v[128:131]
    ds_read_b64_tr_b16 v[68:69], v12 offset:33696
    ds_read_b64_tr_b16 v[70:71], v12 offset:33952
    v_mfma_f32_16x16x32_bf16 v[136:139], v[72:75], v[52:55], v[136:139]
    v_exp_f32 v114, v114
    v_mfma_f32_16x16x32_bf16 v[140:143], v[76:79], v[52:55], v[140:143]
    ds_read_b64_tr_b16 v[72:73], v12 offset:33728
    ds_read_b64_tr_b16 v[74:75], v12 offset:33984
    v_mfma_f32_16x16x32_bf16 v[132:135], v[76:79], v[36:39], v[132:135]
    v_exp_f32 v115, v115
    s_waitcnt lgkmcnt(6)
    v_mfma_f32_16x16x32_bf16 v[128:131], v[80:83], v[40:43], v[128:131]
    ds_read_b64_tr_b16 v[76:77], v12 offset:33760
    ds_read_b64_tr_b16 v[78:79], v12 offset:34016
    v_mfma_f32_16x16x32_bf16 v[136:139], v[80:83], v[56:59], v[136:139]
    v_exp_f32 v116, v116
    v_mfma_f32_16x16x32_bf16 v[140:143], v[84:87], v[56:59], v[140:143]
    ds_read_b64_tr_b16 v[80:81], v12 offset:33792
    ds_read_b64_tr_b16 v[82:83], v12 offset:34048
    v_mfma_f32_16x16x32_bf16 v[132:135], v[84:87], v[40:43], v[132:135]
    v_exp_f32 v117, v117
    v_mfma_f32_16x16x32_bf16 v[128:131], v[88:91], v[44:47], v[128:131]
    ds_read_b64_tr_b16 v[84:85], v12 offset:33824
    ds_read_b64_tr_b16 v[86:87], v12 offset:34080
    v_mfma_f32_16x16x32_bf16 v[136:139], v[88:91], v[60:63], v[136:139]
    v_exp_f32 v118, v118
    v_mfma_f32_16x16x32_bf16 v[140:143], v[92:95], v[60:63], v[140:143]
    ds_read_b64_tr_b16 v[88:89], v12 offset:33856
    ds_read_b64_tr_b16 v[90:91], v12 offset:34112
    v_mfma_f32_16x16x32_bf16 v[132:135], v[92:95], v[44:47], v[132:135]
    v_cvt_pk_bf16_f32 v168, v112, v113
    s_waitcnt lgkmcnt(6)
    v_mfma_f32_16x16x32_bf16 v[192:195], v[64:67], v[160:163], v[192:195]
    ds_read_b64_tr_b16 v[92:93], v12 offset:33888
    ds_read_b64_tr_b16 v[94:95], v12 offset:34144
    v_mfma_f32_16x16x32_bf16 v[196:199], v[64:67], v[164:167], v[196:199]
    v_exp_f32 v119, v119
    v_mfma_f32_16x16x32_bf16 v[108:111], v[4:7], v[164:167], v[108:111]
    v_exp_f32 v120, v120
    v_mfma_f32_16x16x32_bf16 v[104:107], v[4:7], v[160:163], v[104:107]
    v_exp_f32 v121, v121
    v_mfma_f32_16x16x32_bf16 v[200:203], v[68:71], v[160:163], v[200:203]
    ds_read_b128 v[64:67], v10 offset:34176
    v_cvt_pk_bf16_f32 v169, v114, v115
    v_mfma_f32_16x16x32_bf16 v[204:207], v[68:71], v[164:167], v[204:207]
    v_exp_f32 v122, v122
    v_mfma_f32_16x16x32_bf16 v[212:215], v[72:75], v[164:167], v[212:215]
    ds_read_b128 v[68:71], v10 offset:34432
    v_cvt_pk_bf16_f32 v170, v116, v117
    v_mfma_f32_16x16x32_bf16 v[208:211], v[72:75], v[160:163], v[208:211]
    v_exp_f32 v123, v123
    v_mfma_f32_16x16x32_bf16 v[216:219], v[76:79], v[160:163], v[216:219]
    ds_read_b128 v[72:75], v10 offset:34192
    v_cvt_pk_bf16_f32 v171, v118, v119
    v_mfma_f32_16x16x32_bf16 v[220:223], v[76:79], v[164:167], v[220:223]
    v_cvt_pk_bf16_f32 v172, v120, v121
    s_waitcnt lgkmcnt(3)
    v_mfma_f32_16x16x32_bf16 v[228:231], v[80:83], v[164:167], v[228:231]
    ds_read_b128 v[76:79], v10 offset:34448
    v_exp_f32 v124, v124
    v_mfma_f32_16x16x32_bf16 v[224:227], v[80:83], v[160:163], v[224:227]
    v_exp_f32 v125, v125
    v_mfma_f32_16x16x32_bf16 v[232:235], v[84:87], v[160:163], v[232:235]
    ds_read_b128 v[80:83], v10 offset:34208
    v_cvt_pk_bf16_f32 v173, v122, v123
    v_mfma_f32_16x16x32_bf16 v[236:239], v[84:87], v[164:167], v[236:239]
    v_exp_f32 v126, v126
    v_mfma_f32_16x16x32_bf16 v[244:247], v[88:91], v[164:167], v[244:247]
    ds_read_b128 v[84:87], v10 offset:34464
    v_exp_f32 v127, v127
    v_mfma_f32_16x16x32_bf16 v[240:243], v[88:91], v[160:163], v[240:243]
    v_exp_f32 v128, v128
    v_mfma_f32_16x16x32_bf16 v[248:251], v[92:95], v[160:163], v[248:251]
    ds_read_b128 v[88:91], v10 offset:34224
    v_cvt_pk_bf16_f32 v174, v124, v125
    v_mfma_f32_16x16x32_bf16 v[252:255], v[92:95], v[164:167], v[252:255]
    v_cvt_pk_bf16_f32 v175, v126, v127
    s_waitcnt lgkmcnt(3)
    v_mfma_f32_16x16x32_bf16 v[144:147], v[64:67], v[32:35], v[96:99]
    ds_read_b128 v[92:95], v10 offset:34480
    v_exp_f32 v129, v129
    v_mfma_f32_16x16x32_bf16 v[152:155], v[64:67], v[48:51], v[100:103]
    v_exp_f32 v130, v130
    v_mfma_f32_16x16x32_bf16 v[156:159], v[68:71], v[48:51], v[100:103]
    ds_read_b64_tr_b16 v[64:65], v12 offset:34176
    ds_read_b64_tr_b16 v[66:67], v12 offset:34432
    v_mfma_f32_16x16x32_bf16 v[148:151], v[68:71], v[32:35], v[96:99]
    v_exp_f32 v131, v131
    v_mfma_f32_16x16x32_bf16 v[144:147], v[72:75], v[36:39], v[144:147]
    ds_read_b64_tr_b16 v[68:69], v12 offset:34208
    ds_read_b64_tr_b16 v[70:71], v12 offset:34464
    v_mfma_f32_16x16x32_bf16 v[152:155], v[72:75], v[52:55], v[152:155]
    v_exp_f32 v132, v132
    v_mfma_f32_16x16x32_bf16 v[156:159], v[76:79], v[52:55], v[156:159]
    ds_read_b64_tr_b16 v[72:73], v12 offset:34240
    ds_read_b64_tr_b16 v[74:75], v12 offset:34496
    v_mfma_f32_16x16x32_bf16 v[148:151], v[76:79], v[36:39], v[148:151]
    v_cvt_pk_bf16_f32 v176, v128, v129
    s_waitcnt lgkmcnt(6)
    v_mfma_f32_16x16x32_bf16 v[144:147], v[80:83], v[40:43], v[144:147]
    ds_read_b64_tr_b16 v[76:77], v12 offset:34272
    ds_read_b64_tr_b16 v[78:79], v12 offset:34528
    v_mfma_f32_16x16x32_bf16 v[152:155], v[80:83], v[56:59], v[152:155]
    v_exp_f32 v133, v133
    v_mfma_f32_16x16x32_bf16 v[156:159], v[84:87], v[56:59], v[156:159]
    ds_read_b64_tr_b16 v[80:81], v12 offset:34304
    ds_read_b64_tr_b16 v[82:83], v12 offset:34560
    v_mfma_f32_16x16x32_bf16 v[148:151], v[84:87], v[40:43], v[148:151]
    v_exp_f32 v134, v134
    v_mfma_f32_16x16x32_bf16 v[144:147], v[88:91], v[44:47], v[144:147]
    ds_read_b64_tr_b16 v[84:85], v12 offset:34336
    ds_read_b64_tr_b16 v[86:87], v12 offset:34592
    v_mfma_f32_16x16x32_bf16 v[152:155], v[88:91], v[60:63], v[152:155]
    v_exp_f32 v135, v135
    v_mfma_f32_16x16x32_bf16 v[156:159], v[92:95], v[60:63], v[156:159]
    ds_read_b64_tr_b16 v[88:89], v12 offset:34368
    ds_read_b64_tr_b16 v[90:91], v12 offset:34624
    ds_read_b32 v27, v15
    v_mfma_f32_16x16x32_bf16 v[148:151], v[92:95], v[44:47], v[148:151]
    v_cvt_pk_bf16_f32 v177, v130, v131
    s_waitcnt lgkmcnt(7)
    v_mfma_f32_16x16x32_bf16 v[192:195], v[64:67], v[168:171], v[192:195]
    ds_read_b64_tr_b16 v[92:93], v12 offset:34400
    ds_read_b64_tr_b16 v[94:95], v12 offset:34656
    v_mfma_f32_16x16x32_bf16 v[196:199], v[64:67], v[172:175], v[196:199]
    v_exp_f32 v136, v136
    v_mfma_f32_16x16x32_bf16 v[108:111], v[4:7], v[172:175], v[108:111]
    v_exp_f32 v137, v137
    v_mfma_f32_16x16x32_bf16 v[104:107], v[4:7], v[168:171], v[104:107]
    v_exp_f32 v138, v138
    v_mfma_f32_16x16x32_bf16 v[200:203], v[68:71], v[168:171], v[200:203]
    s_waitcnt lgkmcnt(2)
    v_cmp_gt_u32 vcc, 14, v27
    s_cbranch_vccnz L_spinK6
L_backK6:
    ds_read_b128 v[64:67], v11 offset:0
    v_mfma_f32_16x16x32_bf16 v[204:207], v[68:71], v[172:175], v[204:207]
    v_exp_f32 v139, v139
    v_mfma_f32_16x16x32_bf16 v[212:215], v[72:75], v[172:175], v[212:215]
    ds_read_b128 v[68:71], v11 offset:256
    v_cvt_pk_bf16_f32 v178, v132, v133
    v_mfma_f32_16x16x32_bf16 v[208:211], v[72:75], v[168:171], v[208:211]
    v_exp_f32 v140, v140
    v_mfma_f32_16x16x32_bf16 v[216:219], v[76:79], v[168:171], v[216:219]
    ds_read_b128 v[72:75], v11 offset:16
    v_cvt_pk_bf16_f32 v179, v134, v135
    v_mfma_f32_16x16x32_bf16 v[220:223], v[76:79], v[172:175], v[220:223]
    v_cvt_pk_bf16_f32 v180, v136, v137
    s_waitcnt lgkmcnt(3)
    v_mfma_f32_16x16x32_bf16 v[228:231], v[80:83], v[172:175], v[228:231]
    ds_read_b128 v[76:79], v11 offset:272
    v_exp_f32 v141, v141
    v_mfma_f32_16x16x32_bf16 v[224:227], v[80:83], v[168:171], v[224:227]
    v_exp_f32 v142, v142
    v_mfma_f32_16x16x32_bf16 v[232:235], v[84:87], v[168:171], v[232:235]
    ds_read_b128 v[80:83], v11 offset:32
    v_cvt_pk_bf16_f32 v181, v138, v139
    v_mfma_f32_16x16x32_bf16 v[236:239], v[84:87], v[172:175], v[236:239]
    v_exp_f32 v143, v143
    v_mfma_f32_16x16x32_bf16 v[244:247], v[88:91], v[172:175], v[244:247]
    ds_read_b128 v[84:87], v11 offset:288
    v_cvt_pk_bf16_f32 v182, v140, v141
    v_mfma_f32_16x16x32_bf16 v[240:243], v[88:91], v[168:171], v[240:243]
    v_exp_f32 v144, v144
    v_mfma_f32_16x16x32_bf16 v[248:251], v[92:95], v[168:171], v[248:251]
    ds_read_b128 v[88:91], v11 offset:48
    ds_read_b32 v28, v15
    v_mfma_f32_16x16x32_bf16 v[252:255], v[92:95], v[172:175], v[252:255]
    v_cvt_pk_bf16_f32 v183, v142, v143
    s_waitcnt lgkmcnt(4)
    v_mfma_f32_16x16x32_bf16 v[112:115], v[64:67], v[32:35], v[96:99]
    ds_read_b128 v[92:95], v11 offset:304
    v_exp_f32 v145, v145
    v_mfma_f32_16x16x32_bf16 v[120:123], v[64:67], v[48:51], v[100:103]
    v_exp_f32 v146, v146
    v_mfma_f32_16x16x32_bf16 v[124:127], v[68:71], v[48:51], v[100:103]
    s_waitcnt lgkmcnt(1)
    v_cmp_gt_u32 vcc, 15, v28
    s_cbranch_vccnz L_spinV5
L_backV5:
    ds_read_b64_tr_b16 v[64:65], v13 offset:0
    ds_read_b64_tr_b16 v[66:67], v13 offset:256
    v_mfma_f32_16x16x32_bf16 v[116:119], v[68:71], v[32:35], v[96:99]
    v_exp_f32 v147, v147
    v_mfma_f32_16x16x32_bf16 v[112:115], v[72:75], v[36:39], v[112:115]
    ds_read_b64_tr_b16 v[68:69], v13 offset:32
    ds_read_b64_tr_b16 v[70:71], v13 offset:288
    v_mfma_f32_16x16x32_bf16 v[120:123], v[72:75], v[52:55], v[120:123]
    v_exp_f32 v148, v148
    v_mfma_f32_16x16x32_bf16 v[124:127], v[76:79], v[52:55], v[124:127]
    ds_read_b64_tr_b16 v[72:73], v13 offset:64
    ds_read_b64_tr_b16 v[74:75], v13 offset:320
    v_mfma_f32_16x16x32_bf16 v[116:119], v[76:79], v[36:39], v[116:119]
    v_cvt_pk_bf16_f32 v184, v144, v145
    s_waitcnt lgkmcnt(6)
    v_mfma_f32_16x16x32_bf16 v[112:115], v[80:83], v[40:43], v[112:115]
    ds_read_b64_tr_b16 v[76:77], v13 offset:96
    ds_read_b64_tr_b16 v[78:79], v13 offset:352
    v_mfma_f32_16x16x32_bf16 v[120:123], v[80:83], v[56:59], v[120:123]
    v_exp_f32 v149, v149
    v_mfma_f32_16x16x32_bf16 v[124:127], v[84:87], v[56:59], v[124:127]
    ds_read_b64_tr_b16 v[80:81], v13 offset:128
    ds_read_b64_tr_b16 v[82:83], v13 offset:384
    v_mfma_f32_16x16x32_bf16 v[116:119], v[84:87], v[40:43], v[116:119]
    v_exp_f32 v150, v150
    v_mfma_f32_16x16x32_bf16 v[112:115], v[88:91], v[44:47], v[112:115]
    ds_read_b64_tr_b16 v[84:85], v13 offset:160
    ds_read_b64_tr_b16 v[86:87], v13 offset:416
    v_mfma_f32_16x16x32_bf16 v[120:123], v[88:91], v[60:63], v[120:123]
    v_exp_f32 v151, v151
    v_mfma_f32_16x16x32_bf16 v[124:127], v[92:95], v[60:63], v[124:127]
    ds_read_b64_tr_b16 v[88:89], v13 offset:192
    ds_read_b64_tr_b16 v[90:91], v13 offset:448
    v_mfma_f32_16x16x32_bf16 v[116:119], v[92:95], v[44:47], v[116:119]
    v_cvt_pk_bf16_f32 v185, v146, v147
    s_waitcnt lgkmcnt(6)
    v_mfma_f32_16x16x32_bf16 v[192:195], v[64:67], v[176:179], v[192:195]
    ds_read_b64_tr_b16 v[92:93], v13 offset:224
    ds_read_b64_tr_b16 v[94:95], v13 offset:480
    v_mfma_f32_16x16x32_bf16 v[196:199], v[64:67], v[180:183], v[196:199]
    v_exp_f32 v152, v152
    v_mfma_f32_16x16x32_bf16 v[108:111], v[4:7], v[180:183], v[108:111]
    v_exp_f32 v153, v153
    v_mfma_f32_16x16x32_bf16 v[104:107], v[4:7], v[176:179], v[104:107]
    v_exp_f32 v154, v154
    v_mfma_f32_16x16x32_bf16 v[200:203], v[68:71], v[176:179], v[200:203]
    ds_read_b128 v[64:67], v11 offset:512
    v_cvt_pk_bf16_f32 v186, v148, v149
    v_mfma_f32_16x16x32_bf16 v[204:207], v[68:71], v[180:183], v[204:207]
    v_exp_f32 v155, v155
    v_mfma_f32_16x16x32_bf16 v[212:215], v[72:75], v[180:183], v[212:215]
    ds_read_b128 v[68:71], v11 offset:768
    v_cvt_pk_bf16_f32 v187, v150, v151
    v_mfma_f32_16x16x32_bf16 v[208:211], v[72:75], v[176:179], v[208:211]
    v_exp_f32 v156, v156
    v_mfma_f32_16x16x32_bf16 v[216:219], v[76:79], v[176:179], v[216:219]
    ds_read_b128 v[72:75], v11 offset:528
    v_cvt_pk_bf16_f32 v188, v152, v153
    v_mfma_f32_16x16x32_bf16 v[220:223], v[76:79], v[180:183], v[220:223]
    v_exp_f32 v157, v157
    s_waitcnt lgkmcnt(3)
    v_mfma_f32_16x16x32_bf16 v[228:231], v[80:83], v[180:183], v[228:231]
    ds_read_b128 v[76:79], v11 offset:784
    v_cvt_pk_bf16_f32 v189, v154, v155
    v_mfma_f32_16x16x32_bf16 v[224:227], v[80:83], v[176:179], v[224:227]
    v_exp_f32 v158, v158
    v_mfma_f32_16x16x32_bf16 v[232:235], v[84:87], v[176:179], v[232:235]
    ds_read_b128 v[80:83], v11 offset:544
    v_exp_f32 v159, v159
    v_mfma_f32_16x16x32_bf16 v[236:239], v[84:87], v[180:183], v[236:239]
    v_exp_f32 v112, v112
    v_mfma_f32_16x16x32_bf16 v[244:247], v[88:91], v[180:183], v[244:247]
    ds_read_b128 v[84:87], v11 offset:800
    v_cvt_pk_bf16_f32 v190, v156, v157
    v_mfma_f32_16x16x32_bf16 v[240:243], v[88:91], v[176:179], v[240:243]
    v_exp_f32 v113, v113
    v_mfma_f32_16x16x32_bf16 v[248:251], v[92:95], v[176:179], v[248:251]
    ds_read_b128 v[88:91], v11 offset:560
    v_cvt_pk_bf16_f32 v191, v158, v159
    v_mfma_f32_16x16x32_bf16 v[252:255], v[92:95], v[180:183], v[252:255]
    v_exp_f32 v114, v114
    s_waitcnt lgkmcnt(3)
    v_mfma_f32_16x16x32_bf16 v[128:131], v[64:67], v[32:35], v[96:99]
    ds_read_b128 v[92:95], v11 offset:816
    v_exp_f32 v115, v115
    v_mfma_f32_16x16x32_bf16 v[136:139], v[64:67], v[48:51], v[100:103]
    v_exp_f32 v116, v116
    v_mfma_f32_16x16x32_bf16 v[140:143], v[68:71], v[48:51], v[100:103]
    ds_read_b64_tr_b16 v[64:65], v13 offset:512
    ds_read_b64_tr_b16 v[66:67], v13 offset:768
    v_mfma_f32_16x16x32_bf16 v[132:135], v[68:71], v[32:35], v[96:99]
    v_exp_f32 v117, v117
    v_mfma_f32_16x16x32_bf16 v[128:131], v[72:75], v[36:39], v[128:131]
    ds_read_b64_tr_b16 v[68:69], v13 offset:544
    ds_read_b64_tr_b16 v[70:71], v13 offset:800
    v_mfma_f32_16x16x32_bf16 v[136:139], v[72:75], v[52:55], v[136:139]
    v_exp_f32 v118, v118
    v_mfma_f32_16x16x32_bf16 v[140:143], v[76:79], v[52:55], v[140:143]
    ds_read_b64_tr_b16 v[72:73], v13 offset:576
    ds_read_b64_tr_b16 v[74:75], v13 offset:832
    v_mfma_f32_16x16x32_bf16 v[132:135], v[76:79], v[36:39], v[132:135]
    v_cvt_pk_bf16_f32 v160, v112, v113
    s_waitcnt lgkmcnt(6)
    v_mfma_f32_16x16x32_bf16 v[128:131], v[80:83], v[40:43], v[128:131]
    ds_read_b64_tr_b16 v[76:77], v13 offset:608
    ds_read_b64_tr_b16 v[78:79], v13 offset:864
    v_mfma_f32_16x16x32_bf16 v[136:139], v[80:83], v[56:59], v[136:139]
    v_exp_f32 v119, v119
    v_mfma_f32_16x16x32_bf16 v[140:143], v[84:87], v[56:59], v[140:143]
    ds_read_b64_tr_b16 v[80:81], v13 offset:640
    ds_read_b64_tr_b16 v[82:83], v13 offset:896
    v_mfma_f32_16x16x32_bf16 v[132:135], v[84:87], v[40:43], v[132:135]
    v_exp_f32 v120, v120
    v_mfma_f32_16x16x32_bf16 v[128:131], v[88:91], v[44:47], v[128:131]
    ds_read_b64_tr_b16 v[84:85], v13 offset:672
    ds_read_b64_tr_b16 v[86:87], v13 offset:928
    v_mfma_f32_16x16x32_bf16 v[136:139], v[88:91], v[60:63], v[136:139]
    v_exp_f32 v121, v121
    v_mfma_f32_16x16x32_bf16 v[140:143], v[92:95], v[60:63], v[140:143]
    ds_read_b64_tr_b16 v[88:89], v13 offset:704
    ds_read_b64_tr_b16 v[90:91], v13 offset:960
    ds_read_b32 v27, v15
    v_mfma_f32_16x16x32_bf16 v[132:135], v[92:95], v[44:47], v[132:135]
    v_cvt_pk_bf16_f32 v161, v114, v115
    s_waitcnt lgkmcnt(7)
    v_mfma_f32_16x16x32_bf16 v[192:195], v[64:67], v[184:187], v[192:195]
    ds_read_b64_tr_b16 v[92:93], v13 offset:736
    ds_read_b64_tr_b16 v[94:95], v13 offset:992
    v_mfma_f32_16x16x32_bf16 v[196:199], v[64:67], v[188:191], v[196:199]
    v_exp_f32 v122, v122
    v_mfma_f32_16x16x32_bf16 v[108:111], v[4:7], v[188:191], v[108:111]
    v_exp_f32 v123, v123
    v_mfma_f32_16x16x32_bf16 v[104:107], v[4:7], v[184:187], v[104:107]
    v_exp_f32 v124, v124
    v_mfma_f32_16x16x32_bf16 v[200:203], v[68:71], v[184:187], v[200:203]
    s_waitcnt lgkmcnt(2)
    v_cmp_gt_u32 vcc, 16, v27
    s_cbranch_vccnz L_spinK7
L_backK7:
    ds_read_b128 v[64:67], v11 offset:33664
    v_mfma_f32_16x16x32_bf16 v[204:207], v[68:71], v[188:191], v[204:207]
    v_exp_f32 v125, v125
    v_mfma_f32_16x16x32_bf16 v[212:215], v[72:75], v[188:191], v[212:215]
    ds_read_b128 v[68:71], v11 offset:33920
    v_cvt_pk_bf16_f32 v162, v116, v117
    v_mfma_f32_16x16x32_bf16 v[208:211], v[72:75], v[184:187], v[208:211]
    v_exp_f32 v126, v126
    v_mfma_f32_16x16x32_bf16 v[216:219], v[76:79], v[184:187], v[216:219]
    ds_read_b128 v[72:75], v11 offset:33680
    v_cvt_pk_bf16_f32 v163, v118, v119
    v_mfma_f32_16x16x32_bf16 v[220:223], v[76:79], v[188:191], v[220:223]
    v_cvt_pk_bf16_f32 v164, v120, v121
    s_waitcnt lgkmcnt(3)
    v_mfma_f32_16x16x32_bf16 v[228:231], v[80:83], v[188:191], v[228:231]
    ds_read_b128 v[76:79], v11 offset:33936
    v_cvt_pk_bf16_f32 v165, v122, v123
    v_mfma_f32_16x16x32_bf16 v[224:227], v[80:83], v[184:187], v[224:227]
    v_exp_f32 v127, v127
    v_mfma_f32_16x16x32_bf16 v[232:235], v[84:87], v[184:187], v[232:235]
    ds_read_b128 v[80:83], v11 offset:33696
    v_cvt_pk_bf16_f32 v166, v124, v125
    v_mfma_f32_16x16x32_bf16 v[236:239], v[84:87], v[188:191], v[236:239]
    v_exp_f32 v128, v128
    v_mfma_f32_16x16x32_bf16 v[244:247], v[88:91], v[188:191], v[244:247]
    ds_read_b128 v[84:87], v11 offset:33952
    v_cvt_pk_bf16_f32 v167, v126, v127
    v_mfma_f32_16x16x32_bf16 v[240:243], v[88:91], v[184:187], v[240:243]
    v_exp_f32 v129, v129
    v_mfma_f32_16x16x32_bf16 v[248:251], v[92:95], v[184:187], v[248:251]
    ds_read_b128 v[88:91], v11 offset:33712
    v_exp_f32 v130, v130
    v_mfma_f32_16x16x32_bf16 v[252:255], v[92:95], v[188:191], v[252:255]
    v_exp_f32 v131, v131
    s_waitcnt lgkmcnt(3)
    v_mfma_f32_16x16x32_bf16 v[144:147], v[64:67], v[32:35], v[96:99]
    ds_read_b128 v[92:95], v11 offset:33968
    v_cvt_pk_bf16_f32 v168, v128, v129
    v_mfma_f32_16x16x32_bf16 v[152:155], v[64:67], v[48:51], v[100:103]
    v_exp_f32 v132, v132
    v_mfma_f32_16x16x32_bf16 v[156:159], v[68:71], v[48:51], v[100:103]
    ds_read_b128 v[64:67], v11 offset:34176
    v_exp_f32 v133, v133
    v_mfma_f32_16x16x32_bf16 v[148:151], v[68:71], v[32:35], v[96:99]
    v_exp_f32 v134, v134
    v_mfma_f32_16x16x32_bf16 v[144:147], v[72:75], v[36:39], v[144:147]
    ds_read_b128 v[68:71], v11 offset:34432
    v_cvt_pk_bf16_f32 v169, v130, v131
    v_mfma_f32_16x16x32_bf16 v[152:155], v[72:75], v[52:55], v[152:155]
    v_exp_f32 v135, v135
    v_mfma_f32_16x16x32_bf16 v[156:159], v[76:79], v[52:55], v[156:159]
    ds_read_b128 v[72:75], v11 offset:34192
    v_cvt_pk_bf16_f32 v170, v132, v133
    v_mfma_f32_16x16x32_bf16 v[148:151], v[76:79], v[36:39], v[148:151]
    v_exp_f32 v136, v136
    s_waitcnt lgkmcnt(3)
    v_mfma_f32_16x16x32_bf16 v[144:147], v[80:83], v[40:43], v[144:147]
    ds_read_b128 v[76:79], v11 offset:34448
    v_exp_f32 v137, v137
    v_mfma_f32_16x16x32_bf16 v[152:155], v[80:83], v[56:59], v[152:155]
    v_exp_f32 v138, v138
    v_mfma_f32_16x16x32_bf16 v[156:159], v[84:87], v[56:59], v[156:159]
    ds_read_b128 v[80:83], v11 offset:34208
    v_cvt_pk_bf16_f32 v171, v134, v135
    v_mfma_f32_16x16x32_bf16 v[148:151], v[84:87], v[40:43], v[148:151]
    v_exp_f32 v139, v139
    v_mfma_f32_16x16x32_bf16 v[144:147], v[88:91], v[44:47], v[144:147]
    ds_read_b128 v[84:87], v11 offset:34464
    v_cvt_pk_bf16_f32 v172, v136, v137
    v_mfma_f32_16x16x32_bf16 v[152:155], v[88:91], v[60:63], v[152:155]
    v_exp_f32 v140, v140
    v_mfma_f32_16x16x32_bf16 v[156:159], v[92:95], v[60:63], v[156:159]
    ds_read_b128 v[88:91], v11 offset:34224
    ds_read_b32 v28, v15
    v_mfma_f32_16x16x32_bf16 v[148:151], v[92:95], v[44:47], v[148:151]
    v_exp_f32 v141, v141
    s_waitcnt lgkmcnt(4)
    v_mfma_f32_16x16x32_bf16 v[112:115], v[64:67], v[32:35], v[96:99]
    ds_read_b128 v[92:95], v11 offset:34480
    v_cvt_pk_bf16_f32 v173, v138, v139
    v_mfma_f32_16x16x32_bf16 v[120:123], v[64:67], v[48:51], v[100:103]
    v_exp_f32 v142, v142
    v_mfma_f32_16x16x32_bf16 v[124:127], v[68:71], v[48:51], v[100:103]
    s_waitcnt lgkmcnt(1)
    v_cmp_gt_u32 vcc, 17, v28
    s_cbranch_vccnz L_spinV6
L_backV6:
    ds_read_b64_tr_b16 v[64:65], v13 offset:33664
    ds_read_b64_tr_b16 v[66:67], v13 offset:33920
    v_mfma_f32_16x16x32_bf16 v[116:119], v[68:71], v[32:35], v[96:99]
    v_exp_f32 v143, v143
    v_mfma_f32_16x16x32_bf16 v[112:115], v[72:75], v[36:39], v[112:115]
    ds_read_b64_tr_b16 v[68:69], v13 offset:33696
    ds_read_b64_tr_b16 v[70:71], v13 offset:33952
    v_mfma_f32_16x16x32_bf16 v[120:123], v[72:75], v[52:55], v[120:123]
    v_exp_f32 v144, v144
    v_mfma_f32_16x16x32_bf16 v[124:127], v[76:79], v[52:55], v[124:127]
    ds_read_b64_tr_b16 v[72:73], v13 offset:34176
    ds_read_b64_tr_b16 v[74:75], v13 offset:34432
    v_mfma_f32_16x16x32_bf16 v[116:119], v[76:79], v[36:39], v[116:119]
    v_cvt_pk_bf16_f32 v174, v140, v141
    s_waitcnt lgkmcnt(6)
    v_mfma_f32_16x16x32_bf16 v[112:115], v[80:83], v[40:43], v[112:115]
    ds_read_b64_tr_b16 v[76:77], v13 offset:34208
    ds_read_b64_tr_b16 v[78:79], v13 offset:34464
    v_mfma_f32_16x16x32_bf16 v[120:123], v[80:83], v[56:59], v[120:123]
    v_exp_f32 v145, v145
    v_mfma_f32_16x16x32_bf16 v[124:127], v[84:87], v[56:59], v[124:127]
    ds_read_b64_tr_b16 v[80:81], v13 offset:33728
    ds_read_b64_tr_b16 v[82:83], v13 offset:33984
    v_mfma_f32_16x16x32_bf16 v[116:119], v[84:87], v[40:43], v[116:119]
    v_exp_f32 v146, v146
    v_mfma_f32_16x16x32_bf16 v[112:115], v[88:91], v[44:47], v[112:115]
    ds_read_b64_tr_b16 v[84:85], v13 offset:33760
    ds_read_b64_tr_b16 v[86:87], v13 offset:34016
    v_mfma_f32_16x16x32_bf16 v[120:123], v[88:91], v[60:63], v[120:123]
    v_exp_f32 v147, v147
    v_mfma_f32_16x16x32_bf16 v[124:127], v[92:95], v[60:63], v[124:127]
    ds_read_b64_tr_b16 v[88:89], v13 offset:34240
    ds_read_b64_tr_b16 v[90:91], v13 offset:34496
    v_cvt_pk_bf16_f32 v175, v142, v143
    v_mfma_f32_16x16x32_bf16 v[116:119], v[92:95], v[44:47], v[116:119]
    v_exp_f32 v148, v148
    s_waitcnt lgkmcnt(6)
    v_mfma_f32_16x16x32_bf16 v[192:195], v[64:67], v[160:163], v[192:195]
    ds_read_b64_tr_b16 v[92:93], v13 offset:34272
    ds_read_b64_tr_b16 v[94:95], v13 offset:34528
    v_cvt_pk_bf16_f32 v176, v144, v145
    v_mfma_f32_16x16x32_bf16 v[196:199], v[64:67], v[164:167], v[196:199]
    v_exp_f32 v149, v149
    v_cvt_pk_bf16_f32 v177, v146, v147
    v_mfma_f32_16x16x32_bf16 v[108:111], v[4:7], v[164:167], v[108:111]
    v_exp_f32 v150, v150
    v_exp_f32 v151, v151
    v_mfma_f32_16x16x32_bf16 v[104:107], v[4:7], v[160:163], v[104:107]
    v_exp_f32 v152, v152
    v_cvt_pk_bf16_f32 v178, v148, v149
    v_mfma_f32_16x16x32_bf16 v[200:203], v[68:71], v[160:163], v[200:203]
    ds_read_b64_tr_b16 v[64:65], v14 offset:0
    ds_read_b64_tr_b16 v[66:67], v14 offset:256
    v_exp_f32 v153, v153
    v_mfma_f32_16x16x32_bf16 v[204:207], v[68:71], v[164:167], v[204:207]
    v_exp_f32 v154, v154
    v_cvt_pk_bf16_f32 v179, v150, v151
    v_mfma_f32_16x16x32_bf16 v[192:195], v[72:75], v[168:171], v[192:195]
    ds_read_b64_tr_b16 v[68:69], v14 offset:32
    ds_read_b64_tr_b16 v[70:71], v14 offset:288
    v_exp_f32 v155, v155
    v_mfma_f32_16x16x32_bf16 v[196:199], v[72:75], v[172:175], v[196:199]
    v_exp_f32 v156, v156
    v_cvt_pk_bf16_f32 v180, v152, v153
    v_mfma_f32_16x16x32_bf16 v[108:111], v[4:7], v[172:175], v[108:111]
    v_exp_f32 v157, v157
    v_cvt_pk_bf16_f32 v181, v154, v155
    v_mfma_f32_16x16x32_bf16 v[104:107], v[4:7], v[168:171], v[104:107]
    v_exp_f32 v158, v158
    v_exp_f32 v159, v159
    v_mfma_f32_16x16x32_bf16 v[200:203], v[76:79], v[168:171], v[200:203]
    ds_read_b64_tr_b16 v[72:73], v14 offset:512
    ds_read_b64_tr_b16 v[74:75], v14 offset:768
    v_cvt_pk_bf16_f32 v182, v156, v157
    v_mfma_f32_16x16x32_bf16 v[204:207], v[76:79], v[172:175], v[204:207]
    v_exp_f32 v112, v112
    s_waitcnt lgkmcnt(6)
    v_mfma_f32_16x16x32_bf16 v[212:215], v[80:83], v[164:167], v[212:215]
    ds_read_b64_tr_b16 v[76:77], v14 offset:544
    ds_read_b64_tr_b16 v[78:79], v14 offset:800
    v_cvt_pk_bf16_f32 v183, v158, v159
    v_mfma_f32_16x16x32_bf16 v[208:211], v[80:83], v[160:163], v[208:211]
    v_exp_f32 v113, v113
    v_exp_f32 v114, v114
    v_mfma_f32_16x16x32_bf16 v[216:219], v[84:87], v[160:163], v[216:219]
    ds_read_b64_tr_b16 v[80:81], v14 offset:64
    ds_read_b64_tr_b16 v[82:83], v14 offset:320
    v_exp_f32 v115, v115
    v_mfma_f32_16x16x32_bf16 v[220:223], v[84:87], v[164:167], v[220:223]
    v_exp_f32 v116, v116
    v_cvt_pk_bf16_f32 v184, v112, v113
    v_mfma_f32_16x16x32_bf16 v[212:215], v[88:91], v[172:175], v[212:215]
    ds_read_b64_tr_b16 v[84:85], v14 offset:96
    ds_read_b64_tr_b16 v[86:87], v14 offset:352
    v_exp_f32 v117, v117
    v_mfma_f32_16x16x32_bf16 v[208:211], v[88:91], v[168:171], v[208:211]
    v_exp_f32 v118, v118
    v_cvt_pk_bf16_f32 v185, v114, v115
    v_mfma_f32_16x16x32_bf16 v[216:219], v[92:95], v[168:171], v[216:219]
    ds_read_b64_tr_b16 v[88:89], v14 offset:576
    ds_read_b64_tr_b16 v[90:91], v14 offset:832
    v_exp_f32 v119, v119
    v_mfma_f32_16x16x32_bf16 v[220:223], v[92:95], v[172:175], v[220:223]
    v_exp_f32 v120, v120
    s_waitcnt lgkmcnt(6)
    v_mfma_f32_16x16x32_bf16 v[192:195], v[64:67], v[176:179], v[192:195]
    ds_read_b64_tr_b16 v[92:93], v14 offset:608
    ds_read_b64_tr_b16 v[94:95], v14 offset:864
    v_cvt_pk_bf16_f32 v186, v116, v117
    v_mfma_f32_16x16x32_bf16 v[196:199], v[64:67], v[180:183], v[196:199]
    v_exp_f32 v121, v121
    v_cvt_pk_bf16_f32 v187, v118, v119
    v_mfma_f32_16x16x32_bf16 v[108:111], v[4:7], v[180:183], v[108:111]
    v_exp_f32 v122, v122
    v_exp_f32 v123, v123
    v_mfma_f32_16x16x32_bf16 v[104:107], v[4:7], v[176:179], v[104:107]
    v_exp_f32 v124, v124
    v_cvt_pk_bf16_f32 v188, v120, v121
    v_mfma_f32_16x16x32_bf16 v[200:203], v[68:71], v[176:179], v[200:203]
    ds_read_b64_tr_b16 v[64:65], v13 offset:33792
    ds_read_b64_tr_b16 v[66:67], v13 offset:34048
    v_exp_f32 v125, v125
    v_mfma_f32_16x16x32_bf16 v[204:207], v[68:71], v[180:183], v[204:207]
    v_exp_f32 v126, v126
    v_cvt_pk_bf16_f32 v189, v122, v123
    v_exp_f32 v127, v127
    v_cvt_pk_bf16_f32 v190, v124, v125
    v_cvt_pk_bf16_f32 v191, v126, v127
    v_mfma_f32_16x16x32_bf16 v[192:195], v[72:75], v[184:187], v[192:195]
    ds_read_b64_tr_b16 v[68:69], v13 offset:33824
    ds_read_b64_tr_b16 v[70:71], v13 offset:34080
    v_mfma_f32_16x16x32_bf16 v[196:199], v[72:75], v[188:191], v[196:199]
    v_mfma_f32_16x16x32_bf16 v[108:111], v[4:7], v[188:191], v[108:111]
    v_mfma_f32_16x16x32_bf16 v[104:107], v[4:7], v[184:187], v[104:107]
    v_mfma_f32_16x16x32_bf16 v[200:203], v[76:79], v[184:187], v[200:203]
    ds_read_b64_tr_b16 v[72:73], v13 offset:34304
    ds_read_b64_tr_b16 v[74:75], v13 offset:34560
    v_mfma_f32_16x16x32_bf16 v[204:207], v[76:79], v[188:191], v[204:207]
    s_nop 3
    v_add_f32 v8, v104, v108
    v_rcp_f32 v22, v104
    s_waitcnt lgkmcnt(6)
    v_mfma_f32_16x16x32_bf16 v[212:215], v[80:83], v[180:183], v[212:215]
    ds_read_b64_tr_b16 v[76:77], v13 offset:34336
    ds_read_b64_tr_b16 v[78:79], v13 offset:34592
    v_rcp_f32 v24, v108
    v_mfma_f32_16x16x32_bf16 v[208:211], v[80:83], v[176:179], v[208:211]
    v_cmp_nge_f32 vcc, s41, v8
    s_cbranch_vccnz L_slow
    v_mov_b32 v23, v22
    v_mfma_f32_16x16x32_bf16 v[216:219], v[84:87], v[176:179], v[216:219]
    ds_read_b64_tr_b16 v[80:81], v14 offset:128
    ds_read_b64_tr_b16 v[82:83], v14 offset:384
    v_mov_b32 v25, v24
    v_mfma_f32_16x16x32_bf16 v[220:223], v[84:87], v[180:183], v[220:223]
    v_mul_f32 v192, v192, v22
    v_mul_f32 v193, v193, v22
    v_mul_f32 v194, v194, v22
    v_mfma_f32_16x16x32_bf16 v[212:215], v[88:91], v[188:191], v[212:215]
    ds_read_b64_tr_b16 v[84:85], v14 offset:160
    ds_read_b64_tr_b16 v[86:87], v14 offset:416
    v_mul_f32 v195, v195, v22
    v_mfma_f32_16x16x32_bf16 v[208:211], v[88:91], v[184:187], v[208:211]
    v_mul_f32 v196, v196, v24
    v_mul_f32 v197, v197, v24
    v_mul_f32 v198, v198, v24
    v_mfma_f32_16x16x32_bf16 v[216:219], v[92:95], v[184:187], v[216:219]
    ds_read_b64_tr_b16 v[88:89], v14 offset:640
    ds_read_b64_tr_b16 v[90:91], v14 offset:896
    v_mul_f32 v199, v199, v24
    v_mfma_f32_16x16x32_bf16 v[220:223], v[92:95], v[188:191], v[220:223]
    v_mul_f32 v200, v200, v22
    v_mul_f32 v201, v201, v22
    s_waitcnt lgkmcnt(6)
    v_mfma_f32_16x16x32_bf16 v[228:231], v[64:67], v[164:167], v[228:231]
    ds_read_b64_tr_b16 v[92:93], v14 offset:672
    ds_read_b64_tr_b16 v[94:95], v14 offset:928
    v_mul_f32 v202, v202, v22
    v_mfma_f32_16x16x32_bf16 v[224:227], v[64:67], v[160:163], v[224:227]
    v_mul_f32 v203, v203, v22
    v_mul_f32 v204, v204, v24
    v_mul_f32 v205, v205, v24
    v_mfma_f32_16x16x32_bf16 v[232:235], v[68:71], v[160:163], v[232:235]
    ds_read_b64_tr_b16 v[64:65], v13 offset:33856
    ds_read_b64_tr_b16 v[66:67], v13 offset:34112
    v_mul_f32 v206, v206, v24
    v_mfma_f32_16x16x32_bf16 v[236:239], v[68:71], v[164:167], v[236:239]
    v_mul_f32 v207, v207, v24
    v_cvt_pk_bf16_f32 v192, v192, v193
    v_cvt_pk_bf16_f32 v193, v194, v195
    v_mfma_f32_16x16x32_bf16 v[228:231], v[72:75], v[172:175], v[228:231]
    ds_read_b64_tr_b16 v[68:69], v13 offset:33888
    ds_read_b64_tr_b16 v[70:71], v13 offset:34144
    v_cvt_pk_bf16_f32 v194, v196, v197
    v_mfma_f32_16x16x32_bf16 v[224:227], v[72:75], v[168:171], v[224:227]
    v_cvt_pk_bf16_f32 v195, v198, v199
    v_cvt_pk_bf16_f32 v196, v200, v201
    v_cvt_pk_bf16_f32 v197, v202, v203
    v_mfma_f32_16x16x32_bf16 v[232:235], v[76:79], v[168:171], v[232:235]
    ds_read_b64_tr_b16 v[72:73], v13 offset:34368
    ds_read_b64_tr_b16 v[74:75], v13 offset:34624
    v_cvt_pk_bf16_f32 v198, v204, v205
    v_mfma_f32_16x16x32_bf16 v[236:239], v[76:79], v[172:175], v[236:239]
    v_cvt_pk_bf16_f32 v199, v206, v207
    v_permlane32_swap_b32 v192, v194
    s_waitcnt lgkmcnt(6)
    v_mfma_f32_16x16x32_bf16 v[228:231], v[80:83], v[180:183], v[228:231]
    ds_read_b64_tr_b16 v[76:77], v13 offset:34400
    ds_read_b64_tr_b16 v[78:79], v13 offset:34656
    v_permlane32_swap_b32 v193, v195
    v_mfma_f32_16x16x32_bf16 v[224:227], v[80:83], v[176:179], v[224:227]
    v_permlane32_swap_b32 v196, v198
    v_permlane32_swap_b32 v197, v199
    s_mov_b64 vcc, s[76:77]
    v_mfma_f32_16x16x32_bf16 v[232:235], v[84:87], v[176:179], v[232:235]
    ds_read_b64_tr_b16 v[80:81], v14 offset:192
    ds_read_b64_tr_b16 v[82:83], v14 offset:448
    v_cndmask_b32_dpp v200, v194, v192, vcc quad_perm:[1,0,3,2] row_mask:0xf bank_mask:0xf
    v_mfma_f32_16x16x32_bf16 v[236:239], v[84:87], v[180:183], v[236:239]
    v_cndmask_b32_dpp v201, v195, v193, vcc quad_perm:[1,0,3,2] row_mask:0xf bank_mask:0xf
    v_cndmask_b32_dpp v204, v198, v196, vcc quad_perm:[1,0,3,2] row_mask:0xf bank_mask:0xf
    v_cndmask_b32_dpp v205, v199, v197, vcc quad_perm:[1,0,3,2] row_mask:0xf bank_mask:0xf
    v_mfma_f32_16x16x32_bf16 v[228:231], v[88:91], v[188:191], v[228:231]
    ds_read_b64_tr_b16 v[84:85], v14 offset:224
    ds_read_b64_tr_b16 v[86:87], v14 offset:480
    s_mov_b64 vcc, s[78:79]
    v_mfma_f32_16x16x32_bf16 v[224:227], v[88:91], v[184:187], v[224:227]
    v_cndmask_b32_dpp v202, v192, v194, vcc quad_perm:[1,0,3,2] row_mask:0xf bank_mask:0xf
    v_cndmask_b32_dpp v203, v193, v195, vcc quad_perm:[1,0,3,2] row_mask:0xf bank_mask:0xf
    v_cndmask_b32_dpp v206, v196, v198, vcc quad_perm:[1,0,3,2] row_mask:0xf bank_mask:0xf
    v_mfma_f32_16x16x32_bf16 v[232:235], v[92:95], v[184:187], v[232:235]
    ds_read_b64_tr_b16 v[88:89], v14 offset:704
    ds_read_b64_tr_b16 v[90:91], v14 offset:960
    v_cndmask_b32_dpp v207, v197, v199, vcc quad_perm:[1,0,3,2] row_mask:0xf bank_mask:0xf
    v_mfma_f32_16x16x32_bf16 v[236:239], v[92:95], v[188:191], v[236:239]
    s_mov_b64 vcc, s[80:81]
    v_cndmask_b32_dpp v192, v204, v200, vcc quad_perm:[2,3,0,1] row_mask:0xf bank_mask:0xf
    s_waitcnt lgkmcnt(6)
    v_mfma_f32_16x16x32_bf16 v[244:247], v[64:67], v[164:167], v[244:247]
    ds_read_b64_tr_b16 v[92:93], v14 offset:736
    ds_read_b64_tr_b16 v[94:95], v14 offset:992
    v_cndmask_b32_dpp v193, v205, v201, vcc quad_perm:[2,3,0,1] row_mask:0xf bank_mask:0xf
    v_mfma_f32_16x16x32_bf16 v[240:243], v[64:67], v[160:163], v[240:243]
    v_cndmask_b32_dpp v194, v206, v202, vcc quad_perm:[2,3,0,1] row_mask:0xf bank_mask:0xf
    v_cndmask_b32_dpp v195, v207, v203, vcc quad_perm:[2,3,0,1] row_mask:0xf bank_mask:0xf
    s_mov_b64 vcc, s[82:83]
    v_mfma_f32_16x16x32_bf16 v[248:251], v[68:71], v[160:163], v[248:251]
    v_cndmask_b32_dpp v196, v200, v204, vcc quad_perm:[2,3,0,1] row_mask:0xf bank_mask:0xf
    v_cndmask_b32_dpp v197, v201, v205, vcc quad_perm:[2,3,0,1] row_mask:0xf bank_mask:0xf
    v_cndmask_b32_dpp v198, v202, v206, vcc quad_perm:[2,3,0,1] row_mask:0xf bank_mask:0xf
    v_mfma_f32_16x16x32_bf16 v[252:255], v[68:71], v[164:167], v[252:255]
    v_cndmask_b32_dpp v199, v203, v207, vcc quad_perm:[2,3,0,1] row_mask:0xf bank_mask:0xf
    v_permlane16_swap_b32 v192, v194
    v_permlane16_swap_b32 v193, v195
    v_mfma_f32_16x16x32_bf16 v[244:247], v[72:75], v[172:175], v[244:247]
    v_permlane16_swap_b32 v196, v198
    v_permlane16_swap_b32 v197, v199
    s_cbranch_execz L_sk1689
    buffer_store_dwordx4 v[192:195], v26, s[32:35], 0 offen offset:0 sc1
    buffer_store_dwordx4 v[196:199], v26, s[32:35], 0 offen offset:512 sc1
L_sk1689:
    v_mfma_f32_16x16x32_bf16 v[240:243], v[72:75], v[168:171], v[240:243]
    v_mul_f32 v208, v208, v22
    v_mul_f32 v209, v209, v22
    v_mul_f32 v210, v210, v22
    v_mfma_f32_16x16x32_bf16 v[248:251], v[76:79], v[168:171], v[248:251]
    v_mul_f32 v211, v211, v22
    v_mul_f32 v212, v212, v24
    v_mul_f32 v213, v213, v24
    v_mfma_f32_16x16x32_bf16 v[252:255], v[76:79], v[172:175], v[252:255]
    v_mul_f32 v214, v214, v24
    v_mul_f32 v215, v215, v24
    s_waitcnt lgkmcnt(0)
    v_mfma_f32_16x16x32_bf16 v[244:247], v[80:83], v[180:183], v[244:247]
    v_mul_f32 v216, v216, v22
    v_mul_f32 v217, v217, v22
    v_mul_f32 v218, v218, v22
    v_mfma_f32_16x16x32_bf16 v[240:243], v[80:83], v[176:179], v[240:243]
    v_mul_f32 v219, v219, v22
    v_mul_f32 v220, v220, v24
    v_mul_f32 v221, v221, v24
    v_mfma_f32_16x16x32_bf16 v[248:251], v[84:87], v[176:179], v[248:251]
    v_mul_f32 v222, v222, v24
    v_mul_f32 v223, v223, v24
    v_cvt_pk_bf16_f32 v208, v208, v209
    v_mfma_f32_16x16x32_bf16 v[252:255], v[84:87], v[180:183], v[252:255]
    v_cvt_pk_bf16_f32 v209, v210, v211
    v_cvt_pk_bf16_f32 v210, v212, v213
    v_cvt_pk_bf16_f32 v211, v214, v215
    v_mfma_f32_16x16x32_bf16 v[244:247], v[88:91], v[188:191], v[244:247]
    v_cvt_pk_bf16_f32 v212, v216, v217
    v_cvt_pk_bf16_f32 v213, v218, v219
    v_cvt_pk_bf16_f32 v214, v220, v221
    v_mfma_f32_16x16x32_bf16 v[240:243], v[88:91], v[184:187], v[240:243]
    v_cvt_pk_bf16_f32 v215, v222, v223
    v_permlane32_swap_b32 v208, v210
    v_permlane32_swap_b32 v209, v211
    v_mfma_f32_16x16x32_bf16 v[248:251], v[92:95], v[184:187], v[248:251]
    v_permlane32_swap_b32 v212, v214
    v_permlane32_swap_b32 v213, v215
    s_mov_b64 vcc, s[76:77]
    v_mfma_f32_16x16x32_bf16 v[252:255], v[92:95], v[188:191], v[252:255]
    v_cndmask_b32_dpp v216, v210, v208, vcc quad_perm:[1,0,3,2] row_mask:0xf bank_mask:0xf
    v_cndmask_b32_dpp v217, v211, v209, vcc quad_perm:[1,0,3,2] row_mask:0xf bank_mask:0xf
    v_cndmask_b32_dpp v220, v214, v212, vcc quad_perm:[1,0,3,2] row_mask:0xf bank_mask:0xf
    v_cndmask_b32_dpp v221, v215, v213, vcc quad_perm:[1,0,3,2] row_mask:0xf bank_mask:0xf
    s_mov_b64 vcc, s[78:79]
    v_cndmask_b32_dpp v218, v208, v210, vcc quad_perm:[1,0,3,2] row_mask:0xf bank_mask:0xf
    v_cndmask_b32_dpp v219, v209, v211, vcc quad_perm:[1,0,3,2] row_mask:0xf bank_mask:0xf
    v_cndmask_b32_dpp v222, v212, v214, vcc quad_perm:[1,0,3,2] row_mask:0xf bank_mask:0xf
    v_cndmask_b32_dpp v223, v213, v215, vcc quad_perm:[1,0,3,2] row_mask:0xf bank_mask:0xf
    s_mov_b64 vcc, s[80:81]
    v_cndmask_b32_dpp v208, v220, v216, vcc quad_perm:[2,3,0,1] row_mask:0xf bank_mask:0xf
    v_cndmask_b32_dpp v209, v221, v217, vcc quad_perm:[2,3,0,1] row_mask:0xf bank_mask:0xf
    v_cndmask_b32_dpp v210, v222, v218, vcc quad_perm:[2,3,0,1] row_mask:0xf bank_mask:0xf
    v_cndmask_b32_dpp v211, v223, v219, vcc quad_perm:[2,3,0,1] row_mask:0xf bank_mask:0xf
    s_mov_b64 vcc, s[82:83]
    v_cndmask_b32_dpp v212, v216, v220, vcc quad_perm:[2,3,0,1] row_mask:0xf bank_mask:0xf
    v_cndmask_b32_dpp v213, v217, v221, vcc quad_perm:[2,3,0,1] row_mask:0xf bank_mask:0xf
    v_cndmask_b32_dpp v214, v218, v222, vcc quad_perm:[2,3,0,1] row_mask:0xf bank_mask:0xf
    v_cndmask_b32_dpp v215, v219, v223, vcc quad_perm:[2,3,0,1] row_mask:0xf bank_mask:0xf
    v_permlane16_swap_b32 v208, v210
    v_permlane16_swap_b32 v209, v211
    v_permlane16_swap_b32 v212, v214
    v_permlane16_swap_b32 v213, v215
    s_cbranch_execz L_sk1755
    buffer_store_dwordx4 v[208:211], v26, s[32:35], 0 offen offset:64 sc1
    buffer_store_dwordx4 v[212:215], v26, s[32:35], 0 offen offset:576 sc1
L_sk1755:
    v_pk_mul_f32 v[224:225], v[224:225], v[22:23]
    v_pk_mul_f32 v[226:227], v[226:227], v[22:23]
    v_pk_mul_f32 v[228:229], v[228:229], v[24:25]
    v_pk_mul_f32 v[230:231], v[230:231], v[24:25]
    v_pk_mul_f32 v[232:233], v[232:233], v[22:23]
    v_pk_mul_f32 v[234:235], v[234:235], v[22:23]
    v_pk_mul_f32 v[236:237], v[236:237], v[24:25]
    v_pk_mul_f32 v[238:239], v[238:239], v[24:25]
    v_cvt_pk_bf16_f32 v224, v224, v225
    v_cvt_pk_bf16_f32 v225, v226, v227
    v_cvt_pk_bf16_f32 v226, v228, v229
    v_cvt_pk_bf16_f32 v227, v230, v231
    v_cvt_pk_bf16_f32 v228, v232, v233
    v_cvt_pk_bf16_f32 v229, v234, v235
    v_cvt_pk_bf16_f32 v230, v236, v237
    v_cvt_pk_bf16_f32 v231, v238, v239
    v_permlane32_swap_b32 v224, v226
    v_permlane32_swap_b32 v225, v227
    v_permlane32_swap_b32 v228, v230
    v_permlane32_swap_b32 v229, v231
    s_mov_b64 vcc, s[76:77]
    v_cndmask_b32_dpp v232, v226, v224, vcc quad_perm:[1,0,3,2] row_mask:0xf bank_mask:0xf
    v_cndmask_b32_dpp v233, v227, v225, vcc quad_perm:[1,0,3,2] row_mask:0xf bank_mask:0xf
    v_cndmask_b32_dpp v236, v230, v228, vcc quad_perm:[1,0,3,2] row_mask:0xf bank_mask:0xf
    v_cndmask_b32_dpp v237, v231, v229, vcc quad_perm:[1,0,3,2] row_mask:0xf bank_mask:0xf
    s_mov_b64 vcc, s[78:79]
    v_cndmask_b32_dpp v234, v224, v226, vcc quad_perm:[1,0,3,2] row_mask:0xf bank_mask:0xf
    v_cndmask_b32_dpp v235, v225, v227, vcc quad_perm:[1,0,3,2] row_mask:0xf bank_mask:0xf
    v_cndmask_b32_dpp v238, v228, v230, vcc quad_perm:[1,0,3,2] row_mask:0xf bank_mask:0xf
    v_cndmask_b32_dpp v239, v229, v231, vcc quad_perm:[1,0,3,2] row_mask:0xf bank_mask:0xf
    s_mov_b64 vcc, s[80:81]
    v_cndmask_b32_dpp v224, v236, v232, vcc quad_perm:[2,3,0,1] row_mask:0xf bank_mask:0xf
    v_cndmask_b32_dpp v225, v237, v233, vcc quad_perm:[2,3,0,1] row_mask:0xf bank_mask:0xf
    v_cndmask_b32_dpp v226, v238, v234, vcc quad_perm:[2,3,0,1] row_mask:0xf bank_mask:0xf
    v_cndmask_b32_dpp v227, v239, v235, vcc quad_perm:[2,3,0,1] row_mask:0xf bank_mask:0xf
    s_mov_b64 vcc, s[82:83]
    v_cndmask_b32_dpp v228, v232, v236, vcc quad_perm:[2,3,0,1] row_mask:0xf bank_mask:0xf
    v_cndmask_b32_dpp v229, v233, v237, vcc quad_perm:[2,3,0,1] row_mask:0xf bank_mask:0xf
    v_cndmask_b32_dpp v230, v234, v238, vcc quad_perm:[2,3,0,1] row_mask:0xf bank_mask:0xf
    v_cndmask_b32_dpp v231, v235, v239, vcc quad_perm:[2,3,0,1] row_mask:0xf bank_mask:0xf
    v_permlane16_swap_b32 v224, v226
    v_permlane16_swap_b32 v225, v227
    v_permlane16_swap_b32 v228, v230
    v_permlane16_swap_b32 v229, v231
    s_cbranch_execz L_sk1801
    buffer_store_dwordx4 v[224:227], v26, s[32:35], 0 offen offset:128 sc1
    buffer_store_dwordx4 v[228:231], v26, s[32:35], 0 offen offset:640 sc1
L_sk1801:
    v_pk_mul_f32 v[240:241], v[240:241], v[22:23]
    v_pk_mul_f32 v[242:243], v[242:243], v[22:23]
    v_pk_mul_f32 v[244:245], v[244:245], v[24:25]
    v_pk_mul_f32 v[246:247], v[246:247], v[24:25]
    v_pk_mul_f32 v[248:249], v[248:249], v[22:23]
    v_pk_mul_f32 v[250:251], v[250:251], v[22:23]
    v_pk_mul_f32 v[252:253], v[252:253], v[24:25]
    v_pk_mul_f32 v[254:255], v[254:255], v[24:25]
    v_cvt_pk_bf16_f32 v240, v240, v241
    v_cvt_pk_bf16_f32 v241, v242, v243
    v_cvt_pk_bf16_f32 v242, v244, v245
    v_cvt_pk_bf16_f32 v243, v246, v247
    v_cvt_pk_bf16_f32 v244, v248, v249
    v_cvt_pk_bf16_f32 v245, v250, v251
    v_cvt_pk_bf16_f32 v246, v252, v253
    v_cvt_pk_bf16_f32 v247, v254, v255
    v_permlane32_swap_b32 v240, v242
    v_permlane32_swap_b32 v241, v243
    v_permlane32_swap_b32 v244, v246
    v_permlane32_swap_b32 v245, v247
    s_mov_b64 vcc, s[76:77]
    v_cndmask_b32_dpp v248, v242, v240, vcc quad_perm:[1,0,3,2] row_mask:0xf bank_mask:0xf
    v_cndmask_b32_dpp v249, v243, v241, vcc quad_perm:[1,0,3,2] row_mask:0xf bank_mask:0xf
    v_cndmask_b32_dpp v252, v246, v244, vcc quad_perm:[1,0,3,2] row_mask:0xf bank_mask:0xf
    v_cndmask_b32_dpp v253, v247, v245, vcc quad_perm:[1,0,3,2] row_mask:0xf bank_mask:0xf
    s_mov_b64 vcc, s[78:79]
    v_cndmask_b32_dpp v250, v240, v242, vcc quad_perm:[1,0,3,2] row_mask:0xf bank_mask:0xf
    v_cndmask_b32_dpp v251, v241, v243, vcc quad_perm:[1,0,3,2] row_mask:0xf bank_mask:0xf
    v_cndmask_b32_dpp v254, v244, v246, vcc quad_perm:[1,0,3,2] row_mask:0xf bank_mask:0xf
    v_cndmask_b32_dpp v255, v245, v247, vcc quad_perm:[1,0,3,2] row_mask:0xf bank_mask:0xf
    s_mov_b64 vcc, s[80:81]
    v_cndmask_b32_dpp v240, v252, v248, vcc quad_perm:[2,3,0,1] row_mask:0xf bank_mask:0xf
    v_cndmask_b32_dpp v241, v253, v249, vcc quad_perm:[2,3,0,1] row_mask:0xf bank_mask:0xf
    v_cndmask_b32_dpp v242, v254, v250, vcc quad_perm:[2,3,0,1] row_mask:0xf bank_mask:0xf
    v_cndmask_b32_dpp v243, v255, v251, vcc quad_perm:[2,3,0,1] row_mask:0xf bank_mask:0xf
    s_mov_b64 vcc, s[82:83]
    v_cndmask_b32_dpp v244, v248, v252, vcc quad_perm:[2,3,0,1] row_mask:0xf bank_mask:0xf
    v_cndmask_b32_dpp v245, v249, v253, vcc quad_perm:[2,3,0,1] row_mask:0xf bank_mask:0xf
    v_cndmask_b32_dpp v246, v250, v254, vcc quad_perm:[2,3,0,1] row_mask:0xf bank_mask:0xf
    v_cndmask_b32_dpp v247, v251, v255, vcc quad_perm:[2,3,0,1] row_mask:0xf bank_mask:0xf
    v_permlane16_swap_b32 v240, v242
    v_permlane16_swap_b32 v241, v243
    v_permlane16_swap_b32 v244, v246
    v_permlane16_swap_b32 v245, v247
    s_cbranch_execz L_sdone
    buffer_store_dwordx4 v[240:243], v26, s[32:35], 0 offen offset:192 sc1
    buffer_store_dwordx4 v[244:247], v26, s[32:35], 0 offen offset:704 sc1
s_endpgm
L_slow:
    s_cbranch_execz L_sdone
    s_waitcnt vmcnt(0) lgkmcnt(0)
    s_nop 15
    s_nop 15
    v_mov_b32 v19, 0xff800000
    v_mov_b32 v20, 0xff800000
    s_mov_b32 s46, 0
L_s1:
    s_add_u32 s19, s46, 4096
    buffer_load_dwordx4 v[128:131], v30, s[20:23], s46 offen offset:0
    buffer_load_dwordx4 v[132:135], v30, s[20:23], s46 offen offset:16
    buffer_load_dwordx4 v[136:139], v30, s[20:23], s46 offen offset:32
    buffer_load_dwordx4 v[140:143], v30, s[20:23], s46 offen offset:48
    buffer_load_dwordx4 v[144:147], v30, s[20:23], s19 offen offset:0
    buffer_load_dwordx4 v[148:151], v30, s[20:23], s19 offen offset:16
    buffer_load_dwordx4 v[152:155], v30, s[20:23], s19 offen offset:32
    buffer_load_dwordx4 v[156:159], v30, s[20:23], s19 offen offset:48
    s_waitcnt vmcnt(0)
    v_mfma_f32_16x16x32_bf16 v[112:115], v[128:131], v[32:35], 0
    v_mfma_f32_16x16x32_bf16 v[120:123], v[128:131], v[48:51], 0
    v_mfma_f32_16x16x32_bf16 v[112:115], v[132:135], v[36:39], v[112:115]
    v_mfma_f32_16x16x32_bf16 v[120:123], v[132:135], v[52:55], v[120:123]
    v_mfma_f32_16x16x32_bf16 v[112:115], v[136:139], v[40:43], v[112:115]
    v_mfma_f32_16x16x32_bf16 v[120:123], v[136:139], v[56:59], v[120:123]
    v_mfma_f32_16x16x32_bf16 v[112:115], v[140:143], v[44:47], v[112:115]
    v_mfma_f32_16x16x32_bf16 v[120:123], v[140:143], v[60:63], v[120:123]
    v_mfma_f32_16x16x32_bf16 v[116:119], v[144:147], v[32:35], 0
    v_mfma_f32_16x16x32_bf16 v[124:127], v[144:147], v[48:51], 0
    v_mfma_f32_16x16x32_bf16 v[116:119], v[148:151], v[36:39], v[116:119]
    v_mfma_f32_16x16x32_bf16 v[124:127], v[148:151], v[52:55], v[124:127]
    v_mfma_f32_16x16x32_bf16 v[116:119], v[152:155], v[40:43], v[116:119]
    v_mfma_f32_16x16x32_bf16 v[124:127], v[152:155], v[56:59], v[124:127]
    v_mfma_f32_16x16x32_bf16 v[116:119], v[156:159], v[44:47], v[116:119]
    v_mfma_f32_16x16x32_bf16 v[124:127], v[156:159], v[60:63], v[124:127]
    v_max3_f32 v19, v19, v112, v113
    v_max3_f32 v19, v19, v114, v115
    s_nop 4
    v_max3_f32 v19, v19, v116, v117
    v_max3_f32 v19, v19, v118, v119
    v_max3_f32 v20, v20, v120, v121
    v_max3_f32 v20, v20, v122, v123
    v_max3_f32 v20, v20, v124, v125
    v_max3_f32 v20, v20, v126, v127
    s_add_u32 s46, s46, 8192
    s_cmp_lt_u32 s46, 131072
    s_cbranch_scc1 L_s1
    v_mov_b32 v21, v19
    v_mov_b32 v8, v20
    s_nop 0
    v_permlane16_swap_b32 v19, v21
    v_permlane16_swap_b32 v20, v8
    v_max_f32 v19, v19, v21
    v_max_f32 v20, v20, v8
    v_mov_b32 v21, v19
    v_mov_b32 v8, v20
    s_nop 0
    v_permlane32_swap_b32 v19, v21
    v_permlane32_swap_b32 v20, v8
    v_max_f32 v19, v19, v21
    v_max_f32 v20, v20, v8
    v_sub_f32 v17, 0, v19
    v_sub_f32 v18, 0, v20
    v_mov_b32 v104, 0
    v_mov_b32 v105, 0
    v_mov_b32 v106, 0
    v_mov_b32 v107, 0
    v_mov_b32 v108, 0
    v_mov_b32 v109, 0
    v_mov_b32 v110, 0
    v_mov_b32 v111, 0
    v_mov_b32 v192, 0
    v_mov_b32 v193, 0
    v_mov_b32 v194, 0
    v_mov_b32 v195, 0
    v_mov_b32 v196, 0
    v_mov_b32 v197, 0
    v_mov_b32 v198, 0
    v_mov_b32 v199, 0
    v_mov_b32 v200, 0
    v_mov_b32 v201, 0
    v_mov_b32 v202, 0
    v_mov_b32 v203, 0
    v_mov_b32 v204, 0
    v_mov_b32 v205, 0
    v_mov_b32 v206, 0
    v_mov_b32 v207, 0
    v_mov_b32 v208, 0
    v_mov_b32 v209, 0
    v_mov_b32 v210, 0
    v_mov_b32 v211, 0
    v_mov_b32 v212, 0
    v_mov_b32 v213, 0
    v_mov_b32 v214, 0
    v_mov_b32 v215, 0
    v_mov_b32 v216, 0
    v_mov_b32 v217, 0
    v_mov_b32 v218, 0
    v_mov_b32 v219, 0
    v_mov_b32 v220, 0
    v_mov_b32 v221, 0
    v_mov_b32 v222, 0
    v_mov_b32 v223, 0
    v_mov_b32 v224, 0
    v_mov_b32 v225, 0
    v_mov_b32 v226, 0
    v_mov_b32 v227, 0
    v_mov_b32 v228, 0
    v_mov_b32 v229, 0
    v_mov_b32 v230, 0
    v_mov_b32 v231, 0
    v_mov_b32 v232, 0
    v_mov_b32 v233, 0
    v_mov_b32 v234, 0
    v_mov_b32 v235, 0
    v_mov_b32 v236, 0
    v_mov_b32 v237, 0
    v_mov_b32 v238, 0
    v_mov_b32 v239, 0
    v_mov_b32 v240, 0
    v_mov_b32 v241, 0
    v_mov_b32 v242, 0
    v_mov_b32 v243, 0
    v_mov_b32 v244, 0
    v_mov_b32 v245, 0
    v_mov_b32 v246, 0
    v_mov_b32 v247, 0
    v_mov_b32 v248, 0
    v_mov_b32 v249, 0
    v_mov_b32 v250, 0
    v_mov_b32 v251, 0
    v_mov_b32 v252, 0
    v_mov_b32 v253, 0
    v_mov_b32 v254, 0
    v_mov_b32 v255, 0
    s_mov_b32 s46, 0
L_s2:
    s_add_u32 s19, s46, 4096
    buffer_load_dwordx4 v[128:131], v30, s[20:23], s46 offen offset:0
    buffer_load_dwordx4 v[132:135], v30, s[20:23], s46 offen offset:16
    buffer_load_dwordx4 v[136:139], v30, s[20:23], s46 offen offset:32
    buffer_load_dwordx4 v[140:143], v30, s[20:23], s46 offen offset:48
    buffer_load_dwordx4 v[144:147], v30, s[20:23], s19 offen offset:0
    buffer_load_dwordx4 v[148:151], v30, s[20:23], s19 offen offset:16
    buffer_load_dwordx4 v[152:155], v30, s[20:23], s19 offen offset:32
    buffer_load_dwordx4 v[156:159], v30, s[20:23], s19 offen offset:48
    s_waitcnt vmcnt(0)
    v_mfma_f32_16x16x32_bf16 v[112:115], v[128:131], v[32:35], 0
    v_mfma_f32_16x16x32_bf16 v[120:123], v[128:131], v[48:51], 0
    v_mfma_f32_16x16x32_bf16 v[112:115], v[132:135], v[36:39], v[112:115]
    v_mfma_f32_16x16x32_bf16 v[120:123], v[132:135], v[52:55], v[120:123]
    v_mfma_f32_16x16x32_bf16 v[112:115], v[136:139], v[40:43], v[112:115]
    v_mfma_f32_16x16x32_bf16 v[120:123], v[136:139], v[56:59], v[120:123]
    v_mfma_f32_16x16x32_bf16 v[112:115], v[140:143], v[44:47], v[112:115]
    v_mfma_f32_16x16x32_bf16 v[120:123], v[140:143], v[60:63], v[120:123]
    v_mfma_f32_16x16x32_bf16 v[116:119], v[144:147], v[32:35], 0
    v_mfma_f32_16x16x32_bf16 v[124:127], v[144:147], v[48:51], 0
    v_mfma_f32_16x16x32_bf16 v[116:119], v[148:151], v[36:39], v[116:119]
    v_mfma_f32_16x16x32_bf16 v[124:127], v[148:151], v[52:55], v[124:127]
    v_mfma_f32_16x16x32_bf16 v[116:119], v[152:155], v[40:43], v[116:119]
    v_mfma_f32_16x16x32_bf16 v[124:127], v[152:155], v[56:59], v[124:127]
    v_mfma_f32_16x16x32_bf16 v[116:119], v[156:159], v[44:47], v[116:119]
    v_mfma_f32_16x16x32_bf16 v[124:127], v[156:159], v[60:63], v[124:127]
    v_add_f32 v112, v112, v17
    v_add_f32 v113, v113, v17
    v_exp_f32 v112, v112
    v_add_f32 v114, v114, v17
    v_exp_f32 v113, v113
    v_add_f32 v115, v115, v17
    v_exp_f32 v114, v114
    v_add_f32 v116, v116, v17
    v_exp_f32 v115, v115
    v_cvt_pk_bf16_f32 v160, v112, v113
    v_add_f32 v117, v117, v17
    v_exp_f32 v116, v116
    v_add_f32 v118, v118, v17
    v_exp_f32 v117, v117
    v_cvt_pk_bf16_f32 v161, v114, v115
    v_add_f32 v119, v119, v17
    v_exp_f32 v118, v118
    v_add_f32 v120, v120, v18
    v_exp_f32 v119, v119
    v_cvt_pk_bf16_f32 v162, v116, v117
    v_add_f32 v121, v121, v18
    v_exp_f32 v120, v120
    v_add_f32 v122, v122, v18
    v_exp_f32 v121, v121
    v_cvt_pk_bf16_f32 v163, v118, v119
    v_add_f32 v123, v123, v18
    v_exp_f32 v122, v122
    v_add_f32 v124, v124, v18
    v_exp_f32 v123, v123
    v_cvt_pk_bf16_f32 v164, v120, v121
    v_add_f32 v125, v125, v18
    v_exp_f32 v124, v124
    v_add_f32 v126, v126, v18
    v_exp_f32 v125, v125
    v_cvt_pk_bf16_f32 v165, v122, v123
    v_add_f32 v127, v127, v18
    v_exp_f32 v126, v126
    v_exp_f32 v127, v127
    v_cvt_pk_bf16_f32 v166, v124, v125
    v_cvt_pk_bf16_f32 v167, v126, v127
    s_mov_b32 m0, s47
    s_add_u32 s19, s46, 0
    buffer_load_dwordx4 v31, s[24:27], s19 offen lds
    s_add_u32 m0, s47, 1024
    s_add_u32 s19, s19, 2048
    buffer_load_dwordx4 v31, s[24:27], s19 offen lds
    s_waitcnt vmcnt(0)
    ds_read_b64_tr_b16 v[128:129], v9 offset:0
    ds_read_b64_tr_b16 v[132:133], v9 offset:32
    ds_read_b64_tr_b16 v[136:137], v9 offset:64
    ds_read_b64_tr_b16 v[140:141], v9 offset:96
    s_waitcnt lgkmcnt(0)
    s_mov_b32 m0, s47
    s_add_u32 s19, s46, 4096
    buffer_load_dwordx4 v31, s[24:27], s19 offen lds
    s_add_u32 m0, s47, 1024
    s_add_u32 s19, s19, 2048
    buffer_load_dwordx4 v31, s[24:27], s19 offen lds
    s_waitcnt vmcnt(0)
    ds_read_b64_tr_b16 v[130:131], v9 offset:0
    ds_read_b64_tr_b16 v[134:135], v9 offset:32
    ds_read_b64_tr_b16 v[138:139], v9 offset:64
    ds_read_b64_tr_b16 v[142:143], v9 offset:96
    s_waitcnt lgkmcnt(0)
    v_mfma_f32_16x16x32_bf16 v[192:195], v[128:131], v[160:163], v[192:195]
    v_mfma_f32_16x16x32_bf16 v[196:199], v[128:131], v[164:167], v[196:199]
    v_mfma_f32_16x16x32_bf16 v[200:203], v[132:135], v[160:163], v[200:203]
    v_mfma_f32_16x16x32_bf16 v[204:207], v[132:135], v[164:167], v[204:207]
    v_mfma_f32_16x16x32_bf16 v[208:211], v[136:139], v[160:163], v[208:211]
    v_mfma_f32_16x16x32_bf16 v[212:215], v[136:139], v[164:167], v[212:215]
    v_mfma_f32_16x16x32_bf16 v[216:219], v[140:143], v[160:163], v[216:219]
    v_mfma_f32_16x16x32_bf16 v[220:223], v[140:143], v[164:167], v[220:223]
    s_nop 7
    s_mov_b32 m0, s47
    s_add_u32 s19, s46, 128
    buffer_load_dwordx4 v31, s[24:27], s19 offen lds
    s_add_u32 m0, s47, 1024
    s_add_u32 s19, s19, 2048
    buffer_load_dwordx4 v31, s[24:27], s19 offen lds
    s_waitcnt vmcnt(0)
    ds_read_b64_tr_b16 v[128:129], v9 offset:0
    ds_read_b64_tr_b16 v[132:133], v9 offset:32
    ds_read_b64_tr_b16 v[136:137], v9 offset:64
    ds_read_b64_tr_b16 v[140:141], v9 offset:96
    s_waitcnt lgkmcnt(0)
    s_mov_b32 m0, s47
    s_add_u32 s19, s46, 4224
    buffer_load_dwordx4 v31, s[24:27], s19 offen lds
    s_add_u32 m0, s47, 1024
    s_add_u32 s19, s19, 2048
    buffer_load_dwordx4 v31, s[24:27], s19 offen lds
    s_waitcnt vmcnt(0)
    ds_read_b64_tr_b16 v[130:131], v9 offset:0
    ds_read_b64_tr_b16 v[134:135], v9 offset:32
    ds_read_b64_tr_b16 v[138:139], v9 offset:64
    ds_read_b64_tr_b16 v[142:143], v9 offset:96
    s_waitcnt lgkmcnt(0)
    v_mfma_f32_16x16x32_bf16 v[224:227], v[128:131], v[160:163], v[224:227]
    v_mfma_f32_16x16x32_bf16 v[228:231], v[128:131], v[164:167], v[228:231]
    v_mfma_f32_16x16x32_bf16 v[232:235], v[132:135], v[160:163], v[232:235]
    v_mfma_f32_16x16x32_bf16 v[236:239], v[132:135], v[164:167], v[236:239]
    v_mfma_f32_16x16x32_bf16 v[240:243], v[136:139], v[160:163], v[240:243]
    v_mfma_f32_16x16x32_bf16 v[244:247], v[136:139], v[164:167], v[244:247]
    v_mfma_f32_16x16x32_bf16 v[248:251], v[140:143], v[160:163], v[248:251]
    v_mfma_f32_16x16x32_bf16 v[252:255], v[140:143], v[164:167], v[252:255]
    s_nop 7
    v_mfma_f32_16x16x32_bf16 v[104:107], v[4:7], v[160:163], v[104:107]
    v_mfma_f32_16x16x32_bf16 v[108:111], v[4:7], v[164:167], v[108:111]
    s_nop 15
    s_add_u32 s46, s46, 8192
    s_cmp_lt_u32 s46, 131072
    s_cbranch_scc1 L_s2
    v_rcp_f32 v22, v104
    v_rcp_f32 v24, v108
    s_nop 1
    v_mul_f32 v192, v192, v22
    v_mul_f32 v193, v193, v22
    v_mul_f32 v194, v194, v22
    v_mul_f32 v195, v195, v22
    v_mul_f32 v196, v196, v24
    v_mul_f32 v197, v197, v24
    v_mul_f32 v198, v198, v24
    v_mul_f32 v199, v199, v24
    v_mul_f32 v200, v200, v22
    v_mul_f32 v201, v201, v22
    v_mul_f32 v202, v202, v22
    v_mul_f32 v203, v203, v22
    v_mul_f32 v204, v204, v24
    v_mul_f32 v205, v205, v24
    v_mul_f32 v206, v206, v24
    v_mul_f32 v207, v207, v24
    v_cvt_pk_bf16_f32 v192, v192, v193
    v_cvt_pk_bf16_f32 v193, v194, v195
    v_cvt_pk_bf16_f32 v194, v196, v197
    v_cvt_pk_bf16_f32 v195, v198, v199
    v_cvt_pk_bf16_f32 v196, v200, v201
    v_cvt_pk_bf16_f32 v197, v202, v203
    v_cvt_pk_bf16_f32 v198, v204, v205
    v_cvt_pk_bf16_f32 v199, v206, v207
    v_permlane32_swap_b32 v192, v194
    v_permlane32_swap_b32 v193, v195
    v_permlane32_swap_b32 v196, v198
    v_permlane32_swap_b32 v197, v199
    s_mov_b64 vcc, s[76:77]
    v_cndmask_b32_dpp v200, v194, v192, vcc quad_perm:[1,0,3,2] row_mask:0xf bank_mask:0xf
    v_cndmask_b32_dpp v201, v195, v193, vcc quad_perm:[1,0,3,2] row_mask:0xf bank_mask:0xf
    v_cndmask_b32_dpp v204, v198, v196, vcc quad_perm:[1,0,3,2] row_mask:0xf bank_mask:0xf
    v_cndmask_b32_dpp v205, v199, v197, vcc quad_perm:[1,0,3,2] row_mask:0xf bank_mask:0xf
    s_mov_b64 vcc, s[78:79]
    v_cndmask_b32_dpp v202, v192, v194, vcc quad_perm:[1,0,3,2] row_mask:0xf bank_mask:0xf
    v_cndmask_b32_dpp v203, v193, v195, vcc quad_perm:[1,0,3,2] row_mask:0xf bank_mask:0xf
    v_cndmask_b32_dpp v206, v196, v198, vcc quad_perm:[1,0,3,2] row_mask:0xf bank_mask:0xf
    v_cndmask_b32_dpp v207, v197, v199, vcc quad_perm:[1,0,3,2] row_mask:0xf bank_mask:0xf
    s_mov_b64 vcc, s[80:81]
    v_cndmask_b32_dpp v192, v204, v200, vcc quad_perm:[2,3,0,1] row_mask:0xf bank_mask:0xf
    v_cndmask_b32_dpp v193, v205, v201, vcc quad_perm:[2,3,0,1] row_mask:0xf bank_mask:0xf
    v_cndmask_b32_dpp v194, v206, v202, vcc quad_perm:[2,3,0,1] row_mask:0xf bank_mask:0xf
    v_cndmask_b32_dpp v195, v207, v203, vcc quad_perm:[2,3,0,1] row_mask:0xf bank_mask:0xf
    s_mov_b64 vcc, s[82:83]
    v_cndmask_b32_dpp v196, v200, v204, vcc quad_perm:[2,3,0,1] row_mask:0xf bank_mask:0xf
    v_cndmask_b32_dpp v197, v201, v205, vcc quad_perm:[2,3,0,1] row_mask:0xf bank_mask:0xf
    v_cndmask_b32_dpp v198, v202, v206, vcc quad_perm:[2,3,0,1] row_mask:0xf bank_mask:0xf
    v_cndmask_b32_dpp v199, v203, v207, vcc quad_perm:[2,3,0,1] row_mask:0xf bank_mask:0xf
    v_permlane16_swap_b32 v192, v194
    v_permlane16_swap_b32 v193, v195
    v_permlane16_swap_b32 v196, v198
    v_permlane16_swap_b32 v197, v199
    buffer_store_dwordx4 v[192:195], v26, s[32:35], 0 offen offset:0 sc1
    buffer_store_dwordx4 v[196:199], v26, s[32:35], 0 offen offset:512 sc1
    v_mul_f32 v208, v208, v22
    v_mul_f32 v209, v209, v22
    v_mul_f32 v210, v210, v22
    v_mul_f32 v211, v211, v22
    v_mul_f32 v212, v212, v24
    v_mul_f32 v213, v213, v24
    v_mul_f32 v214, v214, v24
    v_mul_f32 v215, v215, v24
    v_mul_f32 v216, v216, v22
    v_mul_f32 v217, v217, v22
    v_mul_f32 v218, v218, v22
    v_mul_f32 v219, v219, v22
    v_mul_f32 v220, v220, v24
    v_mul_f32 v221, v221, v24
    v_mul_f32 v222, v222, v24
    v_mul_f32 v223, v223, v24
    v_cvt_pk_bf16_f32 v208, v208, v209
    v_cvt_pk_bf16_f32 v209, v210, v211
    v_cvt_pk_bf16_f32 v210, v212, v213
    v_cvt_pk_bf16_f32 v211, v214, v215
    v_cvt_pk_bf16_f32 v212, v216, v217
    v_cvt_pk_bf16_f32 v213, v218, v219
    v_cvt_pk_bf16_f32 v214, v220, v221
    v_cvt_pk_bf16_f32 v215, v222, v223
    v_permlane32_swap_b32 v208, v210
    v_permlane32_swap_b32 v209, v211
    v_permlane32_swap_b32 v212, v214
    v_permlane32_swap_b32 v213, v215
    s_mov_b64 vcc, s[76:77]
    v_cndmask_b32_dpp v216, v210, v208, vcc quad_perm:[1,0,3,2] row_mask:0xf bank_mask:0xf
    v_cndmask_b32_dpp v217, v211, v209, vcc quad_perm:[1,0,3,2] row_mask:0xf bank_mask:0xf
    v_cndmask_b32_dpp v220, v214, v212, vcc quad_perm:[1,0,3,2] row_mask:0xf bank_mask:0xf
    v_cndmask_b32_dpp v221, v215, v213, vcc quad_perm:[1,0,3,2] row_mask:0xf bank_mask:0xf
    s_mov_b64 vcc, s[78:79]
    v_cndmask_b32_dpp v218, v208, v210, vcc quad_perm:[1,0,3,2] row_mask:0xf bank_mask:0xf
    v_cndmask_b32_dpp v219, v209, v211, vcc quad_perm:[1,0,3,2] row_mask:0xf bank_mask:0xf
    v_cndmask_b32_dpp v222, v212, v214, vcc quad_perm:[1,0,3,2] row_mask:0xf bank_mask:0xf
    v_cndmask_b32_dpp v223, v213, v215, vcc quad_perm:[1,0,3,2] row_mask:0xf bank_mask:0xf
    s_mov_b64 vcc, s[80:81]
    v_cndmask_b32_dpp v208, v220, v216, vcc quad_perm:[2,3,0,1] row_mask:0xf bank_mask:0xf
    v_cndmask_b32_dpp v209, v221, v217, vcc quad_perm:[2,3,0,1] row_mask:0xf bank_mask:0xf
    v_cndmask_b32_dpp v210, v222, v218, vcc quad_perm:[2,3,0,1] row_mask:0xf bank_mask:0xf
    v_cndmask_b32_dpp v211, v223, v219, vcc quad_perm:[2,3,0,1] row_mask:0xf bank_mask:0xf
    s_mov_b64 vcc, s[82:83]
    v_cndmask_b32_dpp v212, v216, v220, vcc quad_perm:[2,3,0,1] row_mask:0xf bank_mask:0xf
    v_cndmask_b32_dpp v213, v217, v221, vcc quad_perm:[2,3,0,1] row_mask:0xf bank_mask:0xf
    v_cndmask_b32_dpp v214, v218, v222, vcc quad_perm:[2,3,0,1] row_mask:0xf bank_mask:0xf
    v_cndmask_b32_dpp v215, v219, v223, vcc quad_perm:[2,3,0,1] row_mask:0xf bank_mask:0xf
    v_permlane16_swap_b32 v208, v210
    v_permlane16_swap_b32 v209, v211
    v_permlane16_swap_b32 v212, v214
    v_permlane16_swap_b32 v213, v215
    buffer_store_dwordx4 v[208:211], v26, s[32:35], 0 offen offset:64 sc1
    buffer_store_dwordx4 v[212:215], v26, s[32:35], 0 offen offset:576 sc1
    v_mul_f32 v224, v224, v22
    v_mul_f32 v225, v225, v22
    v_mul_f32 v226, v226, v22
    v_mul_f32 v227, v227, v22
    v_mul_f32 v228, v228, v24
    v_mul_f32 v229, v229, v24
    v_mul_f32 v230, v230, v24
    v_mul_f32 v231, v231, v24
    v_mul_f32 v232, v232, v22
    v_mul_f32 v233, v233, v22
    v_mul_f32 v234, v234, v22
    v_mul_f32 v235, v235, v22
    v_mul_f32 v236, v236, v24
    v_mul_f32 v237, v237, v24
    v_mul_f32 v238, v238, v24
    v_mul_f32 v239, v239, v24
    v_cvt_pk_bf16_f32 v224, v224, v225
    v_cvt_pk_bf16_f32 v225, v226, v227
    v_cvt_pk_bf16_f32 v226, v228, v229
    v_cvt_pk_bf16_f32 v227, v230, v231
    v_cvt_pk_bf16_f32 v228, v232, v233
    v_cvt_pk_bf16_f32 v229, v234, v235
    v_cvt_pk_bf16_f32 v230, v236, v237
    v_cvt_pk_bf16_f32 v231, v238, v239
    v_permlane32_swap_b32 v224, v226
    v_permlane32_swap_b32 v225, v227
    v_permlane32_swap_b32 v228, v230
    v_permlane32_swap_b32 v229, v231
    s_mov_b64 vcc, s[76:77]
    v_cndmask_b32_dpp v232, v226, v224, vcc quad_perm:[1,0,3,2] row_mask:0xf bank_mask:0xf
    v_cndmask_b32_dpp v233, v227, v225, vcc quad_perm:[1,0,3,2] row_mask:0xf bank_mask:0xf
    v_cndmask_b32_dpp v236, v230, v228, vcc quad_perm:[1,0,3,2] row_mask:0xf bank_mask:0xf
    v_cndmask_b32_dpp v237, v231, v229, vcc quad_perm:[1,0,3,2] row_mask:0xf bank_mask:0xf
    s_mov_b64 vcc, s[78:79]
    v_cndmask_b32_dpp v234, v224, v226, vcc quad_perm:[1,0,3,2] row_mask:0xf bank_mask:0xf
    v_cndmask_b32_dpp v235, v225, v227, vcc quad_perm:[1,0,3,2] row_mask:0xf bank_mask:0xf
    v_cndmask_b32_dpp v238, v228, v230, vcc quad_perm:[1,0,3,2] row_mask:0xf bank_mask:0xf
    v_cndmask_b32_dpp v239, v229, v231, vcc quad_perm:[1,0,3,2] row_mask:0xf bank_mask:0xf
    s_mov_b64 vcc, s[80:81]
    v_cndmask_b32_dpp v224, v236, v232, vcc quad_perm:[2,3,0,1] row_mask:0xf bank_mask:0xf
    v_cndmask_b32_dpp v225, v237, v233, vcc quad_perm:[2,3,0,1] row_mask:0xf bank_mask:0xf
    v_cndmask_b32_dpp v226, v238, v234, vcc quad_perm:[2,3,0,1] row_mask:0xf bank_mask:0xf
    v_cndmask_b32_dpp v227, v239, v235, vcc quad_perm:[2,3,0,1] row_mask:0xf bank_mask:0xf
    s_mov_b64 vcc, s[82:83]
    v_cndmask_b32_dpp v228, v232, v236, vcc quad_perm:[2,3,0,1] row_mask:0xf bank_mask:0xf
    v_cndmask_b32_dpp v229, v233, v237, vcc quad_perm:[2,3,0,1] row_mask:0xf bank_mask:0xf
    v_cndmask_b32_dpp v230, v234, v238, vcc quad_perm:[2,3,0,1] row_mask:0xf bank_mask:0xf
    v_cndmask_b32_dpp v231, v235, v239, vcc quad_perm:[2,3,0,1] row_mask:0xf bank_mask:0xf
    v_permlane16_swap_b32 v224, v226
    v_permlane16_swap_b32 v225, v227
    v_permlane16_swap_b32 v228, v230
    v_permlane16_swap_b32 v229, v231
    buffer_store_dwordx4 v[224:227], v26, s[32:35], 0 offen offset:128 sc1
    buffer_store_dwordx4 v[228:231], v26, s[32:35], 0 offen offset:640 sc1
    v_mul_f32 v240, v240, v22
    v_mul_f32 v241, v241, v22
    v_mul_f32 v242, v242, v22
    v_mul_f32 v243, v243, v22
    v_mul_f32 v244, v244, v24
    v_mul_f32 v245, v245, v24
    v_mul_f32 v246, v246, v24
    v_mul_f32 v247, v247, v24
    v_mul_f32 v248, v248, v22
    v_mul_f32 v249, v249, v22
    v_mul_f32 v250, v250, v22
    v_mul_f32 v251, v251, v22
    v_mul_f32 v252, v252, v24
    v_mul_f32 v253, v253, v24
    v_mul_f32 v254, v254, v24
    v_mul_f32 v255, v255, v24
    v_cvt_pk_bf16_f32 v240, v240, v241
    v_cvt_pk_bf16_f32 v241, v242, v243
    v_cvt_pk_bf16_f32 v242, v244, v245
    v_cvt_pk_bf16_f32 v243, v246, v247
    v_cvt_pk_bf16_f32 v244, v248, v249
    v_cvt_pk_bf16_f32 v245, v250, v251
    v_cvt_pk_bf16_f32 v246, v252, v253
    v_cvt_pk_bf16_f32 v247, v254, v255
    v_permlane32_swap_b32 v240, v242
    v_permlane32_swap_b32 v241, v243
    v_permlane32_swap_b32 v244, v246
    v_permlane32_swap_b32 v245, v247
    s_mov_b64 vcc, s[76:77]
    v_cndmask_b32_dpp v248, v242, v240, vcc quad_perm:[1,0,3,2] row_mask:0xf bank_mask:0xf
    v_cndmask_b32_dpp v249, v243, v241, vcc quad_perm:[1,0,3,2] row_mask:0xf bank_mask:0xf
    v_cndmask_b32_dpp v252, v246, v244, vcc quad_perm:[1,0,3,2] row_mask:0xf bank_mask:0xf
    v_cndmask_b32_dpp v253, v247, v245, vcc quad_perm:[1,0,3,2] row_mask:0xf bank_mask:0xf
    s_mov_b64 vcc, s[78:79]
    v_cndmask_b32_dpp v250, v240, v242, vcc quad_perm:[1,0,3,2] row_mask:0xf bank_mask:0xf
    v_cndmask_b32_dpp v251, v241, v243, vcc quad_perm:[1,0,3,2] row_mask:0xf bank_mask:0xf
    v_cndmask_b32_dpp v254, v244, v246, vcc quad_perm:[1,0,3,2] row_mask:0xf bank_mask:0xf
    v_cndmask_b32_dpp v255, v245, v247, vcc quad_perm:[1,0,3,2] row_mask:0xf bank_mask:0xf
    s_mov_b64 vcc, s[80:81]
    v_cndmask_b32_dpp v240, v252, v248, vcc quad_perm:[2,3,0,1] row_mask:0xf bank_mask:0xf
    v_cndmask_b32_dpp v241, v253, v249, vcc quad_perm:[2,3,0,1] row_mask:0xf bank_mask:0xf
    v_cndmask_b32_dpp v242, v254, v250, vcc quad_perm:[2,3,0,1] row_mask:0xf bank_mask:0xf
    v_cndmask_b32_dpp v243, v255, v251, vcc quad_perm:[2,3,0,1] row_mask:0xf bank_mask:0xf
    s_mov_b64 vcc, s[82:83]
    v_cndmask_b32_dpp v244, v248, v252, vcc quad_perm:[2,3,0,1] row_mask:0xf bank_mask:0xf
    v_cndmask_b32_dpp v245, v249, v253, vcc quad_perm:[2,3,0,1] row_mask:0xf bank_mask:0xf
    v_cndmask_b32_dpp v246, v250, v254, vcc quad_perm:[2,3,0,1] row_mask:0xf bank_mask:0xf
    v_cndmask_b32_dpp v247, v251, v255, vcc quad_perm:[2,3,0,1] row_mask:0xf bank_mask:0xf
    v_permlane16_swap_b32 v240, v242
    v_permlane16_swap_b32 v241, v243
    v_permlane16_swap_b32 v244, v246
    v_permlane16_swap_b32 v245, v247
    buffer_store_dwordx4 v[240:243], v26, s[32:35], 0 offen offset:192 sc1
    buffer_store_dwordx4 v[244:247], v26, s[32:35], 0 offen offset:704 sc1
    s_endpgm
.section .rodata,"a"
.p2align 6
.amdhsa_kernel standalone__gqa_softmax__near_ridge_kernel
  .amdhsa_next_free_vgpr 256
  .amdhsa_next_free_sgpr 102
  .amdhsa_accum_offset 256
  .amdhsa_group_segment_fixed_size 0
  .amdhsa_kernarg_size 48
  .amdhsa_user_sgpr_count 2
  .amdhsa_user_sgpr_kernarg_segment_ptr 1
  .amdhsa_system_sgpr_workgroup_id_x 1
.end_amdhsa_kernel
```
